```python
import torch

def _softmax(x, axis=-1):
    return torch.softmax(x, dim=axis)
def _gelu(x):
    return torch.nn.functional.gelu(x, approximate="tanh")
def _silu(x):
    return torch.nn.functional.silu(x)
def _sigmoid(x):
    return torch.sigmoid(x)
def _layernorm(x, axis=-1, eps=1e-5):
    m = x.mean(dim=axis, keepdim=True)
    v = x.var(dim=axis, keepdim=True, unbiased=False)
    return (x - m) / torch.sqrt(v + eps)
def _scatter_add(tgt, idx, src, axis=0):
    return tgt.clone().index_add_(axis, idx, src)
def _segment_sum(src, seg, n):
    out = torch.zeros((n,) + src.shape[1:], dtype=src.dtype)
    return out.index_add_(0, seg, src)
def _pad(x, pw):
    flat = tuple(v for pair in reversed(pw) for v in pair)
    return torch.nn.functional.pad(x, flat)

kernel_name = 'standalone__low_rank_proj_linformer__sampling'

def setup_inputs():

    _w = (lambda a: (lambda t: t.to(torch.bfloat16) if t.is_floating_point() else t)(torch.as_tensor(a)))
    B, H, Sq, Skv, Dh, R = 16, 32, 16, 4096, 128, 16
    return {
        "q": _w((lambda *s: torch.randn(*s, dtype=torch.bfloat16) * 0.8)(B, H, Sq, Dh)),
        "k": _w((lambda *s: torch.randn(*s, dtype=torch.bfloat16) * 0.8)(B, H, Skv, Dh)),
        "v": _w((lambda *s: torch.randn(*s, dtype=torch.bfloat16) * 0.05)(B, H, Skv, Dh)),
        "e_proj": _w((lambda *s: torch.randn(*s, dtype=torch.bfloat16) * 0.8)(R, Skv) * (Skv ** -0.5)),
        "f_proj": _w((lambda *s: torch.randn(*s, dtype=torch.bfloat16) * 0.05)(R, Skv) * (Skv ** -0.5)),
    }

def reference(q, k, v, e_proj, f_proj):
    B, H, Sq, Dh = q.shape
    kp = torch.einsum("rn,bhnd->bhrd", e_proj, k)
    vp = torch.einsum("rn,bhnd->bhrd", f_proj, v)
    scores = torch.einsum("bhqd,bhrd->bhqr", q, kp) * (Dh ** -0.5)
    p = _softmax(scores, axis=-1)
    o = torch.einsum("bhqr,bhrd->bhqd", p, vp)
    return o
```

```asm
; @launch grid=(512,1,1) block=(64,1,1) lds=81920
.amdgcn_target "amdgcn-amd-amdhsa--gfx950"
.text
.globl standalone__low_rank_proj_linformer__sampling_kernel
.p2align 8
.type standalone__low_rank_proj_linformer__sampling_kernel,@function
standalone__low_rank_proj_linformer__sampling_kernel:
s_cmp_ge_u32 s2, 512
s_cbranch_scc1 L_end
s_load_dwordx4 s[44:47], s[0:1], 0
s_load_dwordx4 s[48:51], s[0:1], 16
s_load_dwordx4 s[52:55], s[0:1], 32
s_load_dwordx2 s[58:59], s[0:1], 48
s_cmp_lt_u32 s2, 8
s_cbranch_scc0 L_nopf
s_getpc_b64 s[38:39]
L_pc:
v_lshlrev_b32 v64, 7, v0
v_mov_b32 v65, s39
v_min_u32 v66, L_end-L_pc, v64
v_add_co_u32 v66, vcc, s38, v66
v_addc_co_u32 v67, vcc, 0, v65, vcc
global_load_dword v60, v[66:67], off
v_add_u32 v64, 8192, v64
v_min_u32 v66, L_end-L_pc, v64
v_add_co_u32 v66, vcc, s38, v66
v_addc_co_u32 v67, vcc, 0, v65, vcc
global_load_dword v61, v[66:67], off
L_nopf:
v_and_b32 v4, 15, v0
v_lshrrev_b32 v5, 4, v0
s_lshl_b32 s36, s2, 20
s_mov_b32 s22, 0x100000
s_mov_b32 s23, 0x20000
s_mov_b32 s26, 0x20000
s_mov_b32 s27, 0x20000
s_bitcmp1_b32 s2, 0
s_cselect_b32 s35, 373, 0
s_bitcmp1_b32 s2, 1
s_cselect_b32 s37, 53, 0
s_xor_b32 s35, s35, s37
s_bitcmp1_b32 s2, 2
s_cselect_b32 s37, 73, 0
s_xor_b32 s35, s35, s37
s_bitcmp1_b32 s2, 3
s_cselect_b32 s37, 492, 0
s_xor_b32 s35, s35, s37
s_bitcmp1_b32 s2, 4
s_cselect_b32 s37, 89, 0
s_xor_b32 s35, s35, s37
s_bitcmp1_b32 s2, 5
s_cselect_b32 s37, 447, 0
s_xor_b32 s35, s35, s37
s_bitcmp1_b32 s2, 6
s_cselect_b32 s37, 240, 0
s_xor_b32 s35, s35, s37
s_bitcmp1_b32 s2, 7
s_cselect_b32 s37, 122, 0
s_xor_b32 s35, s35, s37
s_bitcmp1_b32 s2, 8
s_cselect_b32 s37, 250, 0
s_xor_b32 s35, s35, s37
v_bfe_i32 v6, v5, 0, 1
v_bfe_i32 v7, v5, 1, 1
v_and_b32 v6, 4, v6
v_and_b32 v7, 36, v7
v_xor_b32 v6, v6, v7
v_lshlrev_b32 v1, 11, v6
v_lshl_add_u32 v1, v4, 4, v1
v_lshlrev_b32 v2, 13, v4
v_lshl_add_u32 v2, v6, 4, v2
s_mov_b32 s34, 0
s_lshl_b32 s28, s35, 11
s_lshl_b32 s29, s35, 4
v_xor_b32 v220, s28, v1
v_xor_b32 v221, s29, v2
s_mov_b32 s78, 0xff1b8075
s_mov_b32 s79, 0x16a14d0
s_waitcnt lgkmcnt(0)
s_add_u32 s20, s46, s36
s_addc_u32 s21, s47, 0
s_and_b32 s21, s21, 0xffff
s_mov_b32 s24, s50
s_and_b32 s25, s51, 0xffff
buffer_load_dwordx4 v[204:207], v221, s[24:27], 0 offen
buffer_load_dwordx4 v[76:79], v220, s[20:23], 0 offen offset:0 nt
buffer_load_dwordx4 v[80:83], v220, s[20:23], 0 offen offset:256 nt
buffer_load_dwordx4 v[84:87], v220, s[20:23], 0 offen offset:512 nt
buffer_load_dwordx4 v[88:91], v220, s[20:23], 0 offen offset:768 nt
buffer_load_dwordx4 v[92:95], v220, s[20:23], 0 offen offset:1024 nt
buffer_load_dwordx4 v[96:99], v220, s[20:23], 0 offen offset:1280 nt
buffer_load_dwordx4 v[100:103], v220, s[20:23], 0 offen offset:1536 nt
buffer_load_dwordx4 v[104:107], v220, s[20:23], 0 offen offset:1792 nt
s_add_u32 s34, s34, 1
s_xor_b32 s35, s35, 0x25
s_lshl_b32 s28, s35, 11
s_lshl_b32 s29, s35, 4
v_xor_b32 v220, s28, v1
v_xor_b32 v221, s29, v2
v_lshlrev_b32 v3, 8, v4
v_lshl_add_u32 v3, v5, 6, v3
s_add_u32 s4, s46, s36
s_addc_u32 s5, s47, 0
s_and_b32 s5, s5, 0xffff
s_mov_b32 s6, 0x100000
s_mov_b32 s7, 0x20000
s_add_u32 s8, s48, s36
s_addc_u32 s9, s49, 0
s_and_b32 s9, s9, 0xffff
s_mov_b32 s10, 0x100000
s_mov_b32 s11, 0x20000
s_mov_b32 s16, s52
s_and_b32 s17, s53, 0xffff
s_mov_b32 s18, 0x20000
s_mov_b32 s19, 0x20000
s_lshl_b32 s36, s2, 12
s_add_u32 s60, s44, s36
s_addc_u32 s61, s45, 0
s_and_b32 s61, s61, 0xffff
s_mov_b32 s62, 0x1000
s_mov_b32 s63, 0x20000
s_add_u32 s64, s54, s36
s_addc_u32 s65, s55, 0
s_and_b32 s65, s65, 0xffff
s_mov_b32 s66, 0x1000
s_mov_b32 s67, 0x20000
buffer_load_dwordx4 v[44:47], v3, s[60:63], 0 offen offset:0 nt
buffer_load_dwordx4 v[48:51], v3, s[60:63], 0 offen offset:16 nt
buffer_load_dwordx4 v[52:55], v3, s[60:63], 0 offen offset:32 nt
buffer_load_dwordx4 v[56:59], v3, s[60:63], 0 offen offset:48 nt
s_waitcnt vmcnt(13)
buffer_load_dwordx4 v[208:211], v221, s[24:27], 0 offen
s_waitcnt vmcnt(13)
buffer_load_dwordx4 v[108:111], v220, s[20:23], 0 offen offset:0 nt
s_waitcnt vmcnt(13)
buffer_load_dwordx4 v[112:115], v220, s[20:23], 0 offen offset:256 nt
s_waitcnt vmcnt(13)
buffer_load_dwordx4 v[116:119], v220, s[20:23], 0 offen offset:512 nt
s_waitcnt vmcnt(13)
buffer_load_dwordx4 v[120:123], v220, s[20:23], 0 offen offset:768 nt
s_waitcnt vmcnt(13)
buffer_load_dwordx4 v[124:127], v220, s[20:23], 0 offen offset:1024 nt
s_waitcnt vmcnt(13)
buffer_load_dwordx4 v[128:131], v220, s[20:23], 0 offen offset:1280 nt
s_waitcnt vmcnt(13)
buffer_load_dwordx4 v[132:135], v220, s[20:23], 0 offen offset:1536 nt
s_waitcnt vmcnt(13)
buffer_load_dwordx4 v[136:139], v220, s[20:23], 0 offen offset:1792 nt
s_add_u32 s34, s34, 1
s_xor_b32 s35, s35, 0x31
s_lshl_b32 s28, s35, 11
s_lshl_b32 s29, s35, 4
v_xor_b32 v220, s28, v1
v_xor_b32 v221, s29, v2
s_waitcnt vmcnt(13)
buffer_load_dwordx4 v[212:215], v221, s[24:27], 0 offen
s_waitcnt vmcnt(13)
buffer_load_dwordx4 v[140:143], v220, s[20:23], 0 offen offset:0 nt
s_waitcnt vmcnt(13)
buffer_load_dwordx4 v[144:147], v220, s[20:23], 0 offen offset:256 nt
s_waitcnt vmcnt(13)
buffer_load_dwordx4 v[148:151], v220, s[20:23], 0 offen offset:512 nt
s_waitcnt vmcnt(13)
buffer_load_dwordx4 v[152:155], v220, s[20:23], 0 offen offset:768 nt
s_waitcnt vmcnt(13)
buffer_load_dwordx4 v[156:159], v220, s[20:23], 0 offen offset:1024 nt
s_waitcnt vmcnt(13)
buffer_load_dwordx4 v[160:163], v220, s[20:23], 0 offen offset:1280 nt
s_waitcnt vmcnt(13)
buffer_load_dwordx4 v[164:167], v220, s[20:23], 0 offen offset:1536 nt
s_waitcnt vmcnt(13)
buffer_load_dwordx4 v[168:171], v220, s[20:23], 0 offen offset:1792 nt
s_add_u32 s34, s34, 1
s_xor_b32 s35, s35, 0x25
s_lshl_b32 s28, s35, 11
s_lshl_b32 s29, s35, 4
v_xor_b32 v220, s28, v1
v_xor_b32 v221, s29, v2
s_waitcnt vmcnt(13)
buffer_load_dwordx4 v[216:219], v221, s[24:27], 0 offen
s_waitcnt vmcnt(13)
buffer_load_dwordx4 v[172:175], v220, s[20:23], 0 offen offset:0 nt
s_waitcnt vmcnt(13)
buffer_load_dwordx4 v[176:179], v220, s[20:23], 0 offen offset:256 nt
s_waitcnt vmcnt(13)
buffer_load_dwordx4 v[180:183], v220, s[20:23], 0 offen offset:512 nt
s_waitcnt vmcnt(13)
buffer_load_dwordx4 v[184:187], v220, s[20:23], 0 offen offset:768 nt
s_waitcnt vmcnt(13)
buffer_load_dwordx4 v[188:191], v220, s[20:23], 0 offen offset:1024 nt
s_waitcnt vmcnt(13)
buffer_load_dwordx4 v[192:195], v220, s[20:23], 0 offen offset:1280 nt
s_waitcnt vmcnt(13)
buffer_load_dwordx4 v[196:199], v220, s[20:23], 0 offen offset:1536 nt
s_waitcnt vmcnt(13)
buffer_load_dwordx4 v[200:203], v220, s[20:23], 0 offen offset:1792 nt
s_add_u32 s34, s34, 1
s_ff1_i32_b32 s36, s34
s_min_u32 s36, s36, 6
s_mul_i32 s36, s36, 12
s_sub_u32 s36, s36, 24
s_lshr_b64 s[36:37], s[78:79], s36
s_and_b32 s36, s36, 4095
s_xor_b32 s35, s35, s36
s_lshl_b32 s28, s35, 11
s_lshl_b32 s29, s35, 4
v_xor_b32 v220, s28, v1
v_xor_b32 v221, s29, v2
s_mov_b32 s31, 0x05040100
s_mov_b32 s32, 0x07060302
s_mov_b32 s92, 0
s_mov_b32 s96, 0
s_mov_b32 s94, 8
s_mov_b32 s88, s58
s_and_b32 s89, s59, 0xffff
s_mov_b32 s90, 256
s_mov_b32 s91, 0x20000
s_lshr_b32 s36, s2, 3
s_and_b32 s93, s36, 3
s_lshl_b32 s93, s93, 2
s_lshr_b32 s93, 8738, s93
s_and_b32 s93, s93, 3
s_sub_u32 s37, s36, 1
s_lshl_b32 s36, s36, 2
s_cmp_lt_u32 s37, 31
s_cselect_b32 s36, s36, 0x40000000
v_mov_b32 v68, 0x40000000
v_mov_b32 v69, s36
v_cmp_eq_u32 vcc, 0, v0
s_nop 0
v_cndmask_b32 v68, v68, v69, vcc
v_lshlrev_b32 v70, 2, v0
v_mov_b32 v69, 0x40000000
v_cmp_gt_u32 vcc, 32, v0
s_nop 0
v_cndmask_b32 v70, v69, v70, vcc
s_getreg_b32 s36, hwreg(HW_REG_XCC_ID, 0, 1)
s_mul_i32 s36, s36, 12
s_sub_i32 s81, 56, s36
s_sub_i32 s87, 6, s36
s_getreg_b32 s82, hwreg(HW_REG_XCC_ID, 0, 3)
s_lshr_b32 s97, s2, 3
s_sub_u32 s37, s97, 1
s_mul_i32 s36, s37, 24
s_add_u32 s36, s36, 32
s_cmp_lt_u32 s37, 9
s_cselect_b32 s84, s36, 0x7fff0000
s_cmp_eq_u32 s97, 1
s_cselect_b32 s84, 32, 0x7fff0000
s_mov_b32 s37, 0
s_mov_b32 s99, 0
s_and_b32 s37, s37, 3
s_lshl_b32 s37, s37, 5
s_add_u32 s37, s37, 128
v_lshlrev_b32 v73, 2, v0
v_add_u32 v73, s37, v73
v_cmp_gt_u32 vcc, 8, v0
s_lshl_b32 s36, s82, 2
s_add_u32 s36, s36, s37
v_cndmask_b32 v73, v69, v73, vcc
v_mov_b32 v74, s36
v_cmp_eq_u32 vcc, 0, v0
s_nop 0
v_cndmask_b32 v72, v69, v74, vcc
v_mov_b32 v74, 0
s_nop 0
v_cndmask_b32 v75, v69, v74, vcc
v_mov_b32 v69, 0
v_mov_b32 v12, 0
v_mov_b32 v13, 0
v_mov_b32 v14, 0
v_mov_b32 v15, 0
v_mov_b32 v16, 0
v_mov_b32 v17, 0
v_mov_b32 v18, 0
v_mov_b32 v19, 0
v_mov_b32 v20, 0
v_mov_b32 v21, 0
v_mov_b32 v22, 0
v_mov_b32 v23, 0
v_mov_b32 v24, 0
v_mov_b32 v25, 0
v_mov_b32 v26, 0
v_mov_b32 v27, 0
v_mov_b32 v28, 0
v_mov_b32 v29, 0
v_mov_b32 v30, 0
v_mov_b32 v31, 0
v_mov_b32 v32, 0
v_mov_b32 v33, 0
v_mov_b32 v34, 0
v_mov_b32 v35, 0
v_mov_b32 v36, 0
v_mov_b32 v37, 0
v_mov_b32 v38, 0
v_mov_b32 v39, 0
v_mov_b32 v40, 0
v_mov_b32 v41, 0
v_mov_b32 v42, 0
v_mov_b32 v43, 0
s_mov_b32 s30, 32
L_loop0:
s_cmp_eq_u32 s30, 1
s_cbranch_scc0 L_nosw0
s_mov_b32 s20, s8
s_mov_b32 s24, s16
s_mov_b32 s21, s9
s_mov_b32 s25, s17
s_mov_b32 s22, s10
s_mov_b32 s26, s18
L_nosw0:
s_waitcnt vmcnt(27)
v_perm_b32 v4, v80, v76, s31
v_perm_b32 v5, v88, v84, s31
v_perm_b32 v6, v96, v92, s31
v_perm_b32 v7, v104, v100, s31
v_perm_b32 v8, v80, v76, s32
v_perm_b32 v9, v88, v84, s32
v_perm_b32 v10, v96, v92, s32
v_perm_b32 v11, v104, v100, s32
v_mfma_f32_16x16x32_bf16 v[12:15], v[4:7], v[204:207], v[12:15]
v_perm_b32 v4, v81, v77, s31
v_perm_b32 v5, v89, v85, s31
v_perm_b32 v6, v97, v93, s31
v_perm_b32 v7, v105, v101, s31
v_mfma_f32_16x16x32_bf16 v[16:19], v[8:11], v[204:207], v[16:19]
v_perm_b32 v8, v81, v77, s32
v_perm_b32 v9, v89, v85, s32
v_perm_b32 v10, v97, v93, s32
v_perm_b32 v11, v105, v101, s32
v_mfma_f32_16x16x32_bf16 v[20:23], v[4:7], v[204:207], v[20:23]
v_perm_b32 v4, v82, v78, s31
v_perm_b32 v5, v90, v86, s31
v_perm_b32 v6, v98, v94, s31
v_perm_b32 v7, v106, v102, s31
v_mfma_f32_16x16x32_bf16 v[24:27], v[8:11], v[204:207], v[24:27]
v_perm_b32 v8, v82, v78, s32
v_perm_b32 v9, v90, v86, s32
v_perm_b32 v10, v98, v94, s32
v_perm_b32 v11, v106, v102, s32
v_mfma_f32_16x16x32_bf16 v[28:31], v[4:7], v[204:207], v[28:31]
v_perm_b32 v4, v83, v79, s31
v_perm_b32 v5, v91, v87, s31
v_perm_b32 v6, v99, v95, s31
v_perm_b32 v7, v107, v103, s31
v_mfma_f32_16x16x32_bf16 v[32:35], v[8:11], v[204:207], v[32:35]
v_perm_b32 v8, v83, v79, s32
v_perm_b32 v9, v91, v87, s32
v_perm_b32 v10, v99, v95, s32
v_perm_b32 v11, v107, v103, s32
v_mfma_f32_16x16x32_bf16 v[36:39], v[4:7], v[204:207], v[36:39]
s_nop 1
v_mfma_f32_16x16x32_bf16 v[40:43], v[8:11], v[204:207], v[40:43]
s_cmp_eq_u32 s93, 0
s_cbranch_scc0 L_np1
v_mov_b32 v71, s92
buffer_store_dword v71, v68, s[88:91], 0 offen
L_np1:
s_mov_b32 s96, s92
buffer_load_dword v69, v70, s[88:91], 0 offen sc1
s_add_u32 s92, s92, 1
s_cmp_ge_u32 s94, 8
s_cbranch_scc1 L_hi1
s_cmp_ge_u32 s94, 4
s_cbranch_scc1 L_ka1
s_waitcnt vmcnt(10)
buffer_load_dwordx4 v[204:207], v221, s[24:27], 0 offen
s_waitcnt vmcnt(10)
buffer_load_dwordx4 v[76:79], v220, s[20:23], 0 offen offset:0 nt
s_waitcnt vmcnt(10)
buffer_load_dwordx4 v[80:83], v220, s[20:23], 0 offen offset:256 nt
s_waitcnt vmcnt(10)
buffer_load_dwordx4 v[84:87], v220, s[20:23], 0 offen offset:512 nt
s_waitcnt vmcnt(10)
buffer_load_dwordx4 v[88:91], v220, s[20:23], 0 offen offset:768 nt
s_waitcnt vmcnt(10)
buffer_load_dwordx4 v[92:95], v220, s[20:23], 0 offen offset:1024 nt
s_waitcnt vmcnt(10)
buffer_load_dwordx4 v[96:99], v220, s[20:23], 0 offen offset:1280 nt
s_waitcnt vmcnt(10)
buffer_load_dwordx4 v[100:103], v220, s[20:23], 0 offen offset:1536 nt
s_waitcnt vmcnt(10)
buffer_load_dwordx4 v[104:107], v220, s[20:23], 0 offen offset:1792 nt
s_branch L_dn1
L_ka1:
s_waitcnt vmcnt(11)
buffer_load_dwordx4 v[204:207], v221, s[24:27], 0 offen
s_waitcnt vmcnt(11)
buffer_load_dwordx4 v[76:79], v220, s[20:23], 0 offen offset:0 nt
s_waitcnt vmcnt(11)
buffer_load_dwordx4 v[80:83], v220, s[20:23], 0 offen offset:256 nt
s_waitcnt vmcnt(11)
buffer_load_dwordx4 v[84:87], v220, s[20:23], 0 offen offset:512 nt
s_waitcnt vmcnt(11)
buffer_load_dwordx4 v[88:91], v220, s[20:23], 0 offen offset:768 nt
s_waitcnt vmcnt(11)
buffer_load_dwordx4 v[92:95], v220, s[20:23], 0 offen offset:1024 nt
s_waitcnt vmcnt(11)
buffer_load_dwordx4 v[96:99], v220, s[20:23], 0 offen offset:1280 nt
s_waitcnt vmcnt(11)
buffer_load_dwordx4 v[100:103], v220, s[20:23], 0 offen offset:1536 nt
s_waitcnt vmcnt(11)
buffer_load_dwordx4 v[104:107], v220, s[20:23], 0 offen offset:1792 nt
s_branch L_dn1
L_hi1:
s_cmp_ge_u32 s94, 12
s_cbranch_scc1 L_kb1
s_waitcnt vmcnt(13)
buffer_load_dwordx4 v[204:207], v221, s[24:27], 0 offen
s_waitcnt vmcnt(13)
buffer_load_dwordx4 v[76:79], v220, s[20:23], 0 offen offset:0 nt
s_waitcnt vmcnt(13)
buffer_load_dwordx4 v[80:83], v220, s[20:23], 0 offen offset:256 nt
s_waitcnt vmcnt(13)
buffer_load_dwordx4 v[84:87], v220, s[20:23], 0 offen offset:512 nt
s_waitcnt vmcnt(13)
buffer_load_dwordx4 v[88:91], v220, s[20:23], 0 offen offset:768 nt
s_waitcnt vmcnt(13)
buffer_load_dwordx4 v[92:95], v220, s[20:23], 0 offen offset:1024 nt
s_waitcnt vmcnt(13)
buffer_load_dwordx4 v[96:99], v220, s[20:23], 0 offen offset:1280 nt
s_waitcnt vmcnt(13)
buffer_load_dwordx4 v[100:103], v220, s[20:23], 0 offen offset:1536 nt
s_waitcnt vmcnt(13)
buffer_load_dwordx4 v[104:107], v220, s[20:23], 0 offen offset:1792 nt
s_branch L_dn1
L_kb1:
s_waitcnt vmcnt(19)
buffer_load_dwordx4 v[204:207], v221, s[24:27], 0 offen
s_waitcnt vmcnt(19)
buffer_load_dwordx4 v[76:79], v220, s[20:23], 0 offen offset:0 nt
s_waitcnt vmcnt(19)
buffer_load_dwordx4 v[80:83], v220, s[20:23], 0 offen offset:256 nt
s_waitcnt vmcnt(19)
buffer_load_dwordx4 v[84:87], v220, s[20:23], 0 offen offset:512 nt
s_waitcnt vmcnt(19)
buffer_load_dwordx4 v[88:91], v220, s[20:23], 0 offen offset:768 nt
s_waitcnt vmcnt(19)
buffer_load_dwordx4 v[92:95], v220, s[20:23], 0 offen offset:1024 nt
s_waitcnt vmcnt(19)
buffer_load_dwordx4 v[96:99], v220, s[20:23], 0 offen offset:1280 nt
s_waitcnt vmcnt(19)
buffer_load_dwordx4 v[100:103], v220, s[20:23], 0 offen offset:1536 nt
s_waitcnt vmcnt(19)
buffer_load_dwordx4 v[104:107], v220, s[20:23], 0 offen offset:1792 nt
L_dn1:
s_add_u32 s34, s34, 1
s_xor_b32 s35, s35, 0x25
s_lshl_b32 s28, s35, 11
s_lshl_b32 s29, s35, 4
v_xor_b32 v220, s28, v1
v_xor_b32 v221, s29, v2
s_waitcnt vmcnt(27)
v_perm_b32 v4, v112, v108, s31
v_perm_b32 v5, v120, v116, s31
v_perm_b32 v6, v128, v124, s31
v_perm_b32 v7, v136, v132, s31
v_perm_b32 v8, v112, v108, s32
v_perm_b32 v9, v120, v116, s32
v_perm_b32 v10, v128, v124, s32
v_perm_b32 v11, v136, v132, s32
v_mfma_f32_16x16x32_bf16 v[12:15], v[4:7], v[208:211], v[12:15]
v_perm_b32 v4, v113, v109, s31
v_perm_b32 v5, v121, v117, s31
v_perm_b32 v6, v129, v125, s31
v_perm_b32 v7, v137, v133, s31
v_mfma_f32_16x16x32_bf16 v[16:19], v[8:11], v[208:211], v[16:19]
v_perm_b32 v8, v113, v109, s32
v_perm_b32 v9, v121, v117, s32
v_perm_b32 v10, v129, v125, s32
v_perm_b32 v11, v137, v133, s32
v_mfma_f32_16x16x32_bf16 v[20:23], v[4:7], v[208:211], v[20:23]
v_perm_b32 v4, v114, v110, s31
v_perm_b32 v5, v122, v118, s31
v_perm_b32 v6, v130, v126, s31
v_perm_b32 v7, v138, v134, s31
v_mfma_f32_16x16x32_bf16 v[24:27], v[8:11], v[208:211], v[24:27]
v_perm_b32 v8, v114, v110, s32
v_perm_b32 v9, v122, v118, s32
v_perm_b32 v10, v130, v126, s32
v_perm_b32 v11, v138, v134, s32
v_mfma_f32_16x16x32_bf16 v[28:31], v[4:7], v[208:211], v[28:31]
v_perm_b32 v4, v115, v111, s31
v_perm_b32 v5, v123, v119, s31
v_perm_b32 v6, v131, v127, s31
v_perm_b32 v7, v139, v135, s31
v_mfma_f32_16x16x32_bf16 v[32:35], v[8:11], v[208:211], v[32:35]
v_perm_b32 v8, v115, v111, s32
v_perm_b32 v9, v123, v119, s32
v_perm_b32 v10, v131, v127, s32
v_perm_b32 v11, v139, v135, s32
v_mfma_f32_16x16x32_bf16 v[36:39], v[4:7], v[208:211], v[36:39]
s_nop 1
v_mfma_f32_16x16x32_bf16 v[40:43], v[8:11], v[208:211], v[40:43]
s_cmp_eq_u32 s93, 1
s_cbranch_scc0 L_np2
v_mov_b32 v71, s92
buffer_store_dword v71, v68, s[88:91], 0 offen
L_np2:
s_add_u32 s92, s92, 1
s_cmp_ge_u32 s94, 7
s_cbranch_scc1 L_hi2
s_cmp_ge_u32 s94, 3
s_cbranch_scc1 L_ka2
s_waitcnt vmcnt(10)
buffer_load_dwordx4 v[208:211], v221, s[24:27], 0 offen
s_waitcnt vmcnt(10)
buffer_load_dwordx4 v[108:111], v220, s[20:23], 0 offen offset:0 nt
s_waitcnt vmcnt(10)
buffer_load_dwordx4 v[112:115], v220, s[20:23], 0 offen offset:256 nt
s_waitcnt vmcnt(10)
buffer_load_dwordx4 v[116:119], v220, s[20:23], 0 offen offset:512 nt
s_waitcnt vmcnt(10)
buffer_load_dwordx4 v[120:123], v220, s[20:23], 0 offen offset:768 nt
s_waitcnt vmcnt(10)
buffer_load_dwordx4 v[124:127], v220, s[20:23], 0 offen offset:1024 nt
s_waitcnt vmcnt(10)
buffer_load_dwordx4 v[128:131], v220, s[20:23], 0 offen offset:1280 nt
s_waitcnt vmcnt(10)
buffer_load_dwordx4 v[132:135], v220, s[20:23], 0 offen offset:1536 nt
s_waitcnt vmcnt(10)
buffer_load_dwordx4 v[136:139], v220, s[20:23], 0 offen offset:1792 nt
s_branch L_dn2
L_ka2:
s_waitcnt vmcnt(11)
buffer_load_dwordx4 v[208:211], v221, s[24:27], 0 offen
s_waitcnt vmcnt(11)
buffer_load_dwordx4 v[108:111], v220, s[20:23], 0 offen offset:0 nt
s_waitcnt vmcnt(11)
buffer_load_dwordx4 v[112:115], v220, s[20:23], 0 offen offset:256 nt
s_waitcnt vmcnt(11)
buffer_load_dwordx4 v[116:119], v220, s[20:23], 0 offen offset:512 nt
s_waitcnt vmcnt(11)
buffer_load_dwordx4 v[120:123], v220, s[20:23], 0 offen offset:768 nt
s_waitcnt vmcnt(11)
buffer_load_dwordx4 v[124:127], v220, s[20:23], 0 offen offset:1024 nt
s_waitcnt vmcnt(11)
buffer_load_dwordx4 v[128:131], v220, s[20:23], 0 offen offset:1280 nt
s_waitcnt vmcnt(11)
buffer_load_dwordx4 v[132:135], v220, s[20:23], 0 offen offset:1536 nt
s_waitcnt vmcnt(11)
buffer_load_dwordx4 v[136:139], v220, s[20:23], 0 offen offset:1792 nt
s_branch L_dn2
L_hi2:
s_cmp_ge_u32 s94, 11
s_cbranch_scc1 L_kb2
s_waitcnt vmcnt(13)
buffer_load_dwordx4 v[208:211], v221, s[24:27], 0 offen
s_waitcnt vmcnt(13)
buffer_load_dwordx4 v[108:111], v220, s[20:23], 0 offen offset:0 nt
s_waitcnt vmcnt(13)
buffer_load_dwordx4 v[112:115], v220, s[20:23], 0 offen offset:256 nt
s_waitcnt vmcnt(13)
buffer_load_dwordx4 v[116:119], v220, s[20:23], 0 offen offset:512 nt
s_waitcnt vmcnt(13)
buffer_load_dwordx4 v[120:123], v220, s[20:23], 0 offen offset:768 nt
s_waitcnt vmcnt(13)
buffer_load_dwordx4 v[124:127], v220, s[20:23], 0 offen offset:1024 nt
s_waitcnt vmcnt(13)
buffer_load_dwordx4 v[128:131], v220, s[20:23], 0 offen offset:1280 nt
s_waitcnt vmcnt(13)
buffer_load_dwordx4 v[132:135], v220, s[20:23], 0 offen offset:1536 nt
s_waitcnt vmcnt(13)
buffer_load_dwordx4 v[136:139], v220, s[20:23], 0 offen offset:1792 nt
s_branch L_dn2
L_kb2:
s_waitcnt vmcnt(19)
buffer_load_dwordx4 v[208:211], v221, s[24:27], 0 offen
s_waitcnt vmcnt(19)
buffer_load_dwordx4 v[108:111], v220, s[20:23], 0 offen offset:0 nt
s_waitcnt vmcnt(19)
buffer_load_dwordx4 v[112:115], v220, s[20:23], 0 offen offset:256 nt
s_waitcnt vmcnt(19)
buffer_load_dwordx4 v[116:119], v220, s[20:23], 0 offen offset:512 nt
s_waitcnt vmcnt(19)
buffer_load_dwordx4 v[120:123], v220, s[20:23], 0 offen offset:768 nt
s_waitcnt vmcnt(19)
buffer_load_dwordx4 v[124:127], v220, s[20:23], 0 offen offset:1024 nt
s_waitcnt vmcnt(19)
buffer_load_dwordx4 v[128:131], v220, s[20:23], 0 offen offset:1280 nt
s_waitcnt vmcnt(19)
buffer_load_dwordx4 v[132:135], v220, s[20:23], 0 offen offset:1536 nt
s_waitcnt vmcnt(19)
buffer_load_dwordx4 v[136:139], v220, s[20:23], 0 offen offset:1792 nt
L_dn2:
s_add_u32 s34, s34, 1
s_xor_b32 s35, s35, 0x31
s_lshl_b32 s28, s35, 11
s_lshl_b32 s29, s35, 4
v_xor_b32 v220, s28, v1
v_xor_b32 v221, s29, v2
s_waitcnt vmcnt(27)
v_perm_b32 v4, v144, v140, s31
v_perm_b32 v5, v152, v148, s31
v_perm_b32 v6, v160, v156, s31
v_perm_b32 v7, v168, v164, s31
v_perm_b32 v8, v144, v140, s32
v_perm_b32 v9, v152, v148, s32
v_perm_b32 v10, v160, v156, s32
v_perm_b32 v11, v168, v164, s32
v_mfma_f32_16x16x32_bf16 v[12:15], v[4:7], v[212:215], v[12:15]
v_perm_b32 v4, v145, v141, s31
v_perm_b32 v5, v153, v149, s31
v_perm_b32 v6, v161, v157, s31
v_perm_b32 v7, v169, v165, s31
v_mfma_f32_16x16x32_bf16 v[16:19], v[8:11], v[212:215], v[16:19]
v_perm_b32 v8, v145, v141, s32
v_perm_b32 v9, v153, v149, s32
v_perm_b32 v10, v161, v157, s32
v_perm_b32 v11, v169, v165, s32
v_mfma_f32_16x16x32_bf16 v[20:23], v[4:7], v[212:215], v[20:23]
v_perm_b32 v4, v146, v142, s31
v_perm_b32 v5, v154, v150, s31
v_perm_b32 v6, v162, v158, s31
v_perm_b32 v7, v170, v166, s31
v_mfma_f32_16x16x32_bf16 v[24:27], v[8:11], v[212:215], v[24:27]
v_perm_b32 v8, v146, v142, s32
v_perm_b32 v9, v154, v150, s32
v_perm_b32 v10, v162, v158, s32
v_perm_b32 v11, v170, v166, s32
v_mfma_f32_16x16x32_bf16 v[28:31], v[4:7], v[212:215], v[28:31]
v_perm_b32 v4, v147, v143, s31
v_perm_b32 v5, v155, v151, s31
v_perm_b32 v6, v163, v159, s31
v_perm_b32 v7, v171, v167, s31
v_mfma_f32_16x16x32_bf16 v[32:35], v[8:11], v[212:215], v[32:35]
v_perm_b32 v8, v147, v143, s32
v_perm_b32 v9, v155, v151, s32
v_perm_b32 v10, v163, v159, s32
v_perm_b32 v11, v171, v167, s32
v_mfma_f32_16x16x32_bf16 v[36:39], v[4:7], v[212:215], v[36:39]
s_nop 1
v_mfma_f32_16x16x32_bf16 v[40:43], v[8:11], v[212:215], v[40:43]
s_waitcnt vmcnt(18)
v_add_u32_dpp v63, v69, v69 row_shr:1 row_mask:0xf bank_mask:0xf bound_ctrl:0
s_nop 1
v_add_u32_dpp v63, v63, v63 row_shr:2 row_mask:0xf bank_mask:0xf bound_ctrl:0
s_nop 1
v_add_u32_dpp v63, v63, v63 row_shr:4 row_mask:0xf bank_mask:0xf bound_ctrl:0
s_nop 1
v_add_u32_dpp v63, v63, v63 row_shr:8 row_mask:0xf bank_mask:0xf bound_ctrl:0
s_nop 1
v_readlane_b32 s95, v63, 15
v_readlane_b32 s36, v63, 31
s_mul_i32 s37, s96, 31
s_add_i32 s95, s95, s36
s_sub_i32 s36, s37, s95
v_readlane_b32 s85, v69, 0
s_sub_i32 s36, s36, 50
s_add_i32 s36, s36, s85
s_add_i32 s85, s85, s87
s_cmp_ge_u32 s96, 224
s_cselect_b32 s37, 8, 4
s_mul_i32 s36, s36, s37
s_cselect_b32 s37, 7, 6
s_mul_i32 s85, s85, s37
s_sub_i32 s36, s36, s85
s_ashr_i32 s36, s36, 6
s_sub_i32 s36, 6, s36
s_cmp_lt_u32 s96, 8
s_cselect_b32 s37, 2, 0
s_add_i32 s36, s36, s37
s_max_i32 s36, s36, 0
s_min_i32 s94, s36, 12
s_sub_u32 s36, s96, s84
s_cmp_le_u32 s36, 12
s_cbranch_scc0 L_gxd3
s_cmp_eq_u32 s36, 0
s_cbranch_scc0 L_gx13
s_memrealtime s[100:101]
v_readlane_b32 s37, v69, 0
s_mul_i32 s36, s96, 31
s_sub_i32 s37, s95, s37
s_sub_i32 s37, s37, s36
s_mul_i32 s37, s37, 57
s_ashr_i32 s37, s37, 5
s_waitcnt lgkmcnt(0)
s_sub_u32 s98, s100, s37
v_mov_b32 v63, s98
buffer_atomic_swap v63, v72, s[88:91], 0 offen sc1
s_branch L_gxd3
L_gx13:
s_cmp_eq_u32 s36, 8
s_cbranch_scc0 L_gx23
buffer_load_dword v74, v73, s[88:91], 0 offen sc1
s_branch L_gxd3
L_gx23:
s_cmp_eq_u32 s36, 12
s_cbranch_scc0 L_gxd3
v_subrev_u32 v63, s98, v74
s_mov_b32 s36, 1200
v_add_u32 v74, 600, v63
v_cmp_ge_u32 vcc, s36, v74
s_nop 3
s_and_b32 s36, vcc_lo, 0xff
s_cmp_eq_u32 s36, 0xff
s_cbranch_scc0 L_gxa3
v_add_u32_dpp v63, v63, v63 row_shr:1 row_mask:0xf bank_mask:0xf bound_ctrl:0
s_nop 1
v_add_u32_dpp v63, v63, v63 row_shr:2 row_mask:0xf bank_mask:0xf bound_ctrl:0
s_nop 1
v_add_u32_dpp v63, v63, v63 row_shr:4 row_mask:0xf bank_mask:0xf bound_ctrl:0
s_nop 1
v_readlane_b32 s36, v63, 7
s_nop 0
s_mul_i32 s37, s36, -2
s_ashr_i32 s37, s37, 9
s_add_i32 s99, s99, s37
s_max_i32 s99, s99, -60
s_min_i32 s99, s99, 60
s_mul_i32 s36, s36, -12
s_ashr_i32 s36, s36, 9
s_add_i32 s36, s36, s99
s_max_i32 s36, s36, -80
s_min_i32 s36, s36, 80
v_mov_b32 v63, s36
buffer_store_dword v63, v75, s[88:91], 0 offen
L_gxa3:
s_add_u32 s84, s84, 24
s_cmp_ge_u32 s84, 248
s_cselect_b32 s84, 0x7fff0000, s84
v_xor_b32 v72, 32, v72
v_xor_b32 v73, 32, v73
L_gxd3:
s_cmp_eq_u32 s93, 2
s_cbranch_scc0 L_np3
v_mov_b32 v71, s92
buffer_store_dword v71, v68, s[88:91], 0 offen
L_np3:
s_add_u32 s92, s92, 1
s_cmp_ge_u32 s94, 6
s_cbranch_scc1 L_hi3
s_cmp_ge_u32 s94, 2
s_cbranch_scc1 L_ka3
s_waitcnt vmcnt(10)
buffer_load_dwordx4 v[212:215], v221, s[24:27], 0 offen
s_waitcnt vmcnt(10)
buffer_load_dwordx4 v[140:143], v220, s[20:23], 0 offen offset:0 nt
s_waitcnt vmcnt(10)
buffer_load_dwordx4 v[144:147], v220, s[20:23], 0 offen offset:256 nt
s_waitcnt vmcnt(10)
buffer_load_dwordx4 v[148:151], v220, s[20:23], 0 offen offset:512 nt
s_waitcnt vmcnt(10)
buffer_load_dwordx4 v[152:155], v220, s[20:23], 0 offen offset:768 nt
s_waitcnt vmcnt(10)
buffer_load_dwordx4 v[156:159], v220, s[20:23], 0 offen offset:1024 nt
s_waitcnt vmcnt(10)
buffer_load_dwordx4 v[160:163], v220, s[20:23], 0 offen offset:1280 nt
s_waitcnt vmcnt(10)
buffer_load_dwordx4 v[164:167], v220, s[20:23], 0 offen offset:1536 nt
s_waitcnt vmcnt(10)
buffer_load_dwordx4 v[168:171], v220, s[20:23], 0 offen offset:1792 nt
s_branch L_dn3
L_ka3:
s_waitcnt vmcnt(11)
buffer_load_dwordx4 v[212:215], v221, s[24:27], 0 offen
s_waitcnt vmcnt(11)
buffer_load_dwordx4 v[140:143], v220, s[20:23], 0 offen offset:0 nt
s_waitcnt vmcnt(11)
buffer_load_dwordx4 v[144:147], v220, s[20:23], 0 offen offset:256 nt
s_waitcnt vmcnt(11)
buffer_load_dwordx4 v[148:151], v220, s[20:23], 0 offen offset:512 nt
s_waitcnt vmcnt(11)
buffer_load_dwordx4 v[152:155], v220, s[20:23], 0 offen offset:768 nt
s_waitcnt vmcnt(11)
buffer_load_dwordx4 v[156:159], v220, s[20:23], 0 offen offset:1024 nt
s_waitcnt vmcnt(11)
buffer_load_dwordx4 v[160:163], v220, s[20:23], 0 offen offset:1280 nt
s_waitcnt vmcnt(11)
buffer_load_dwordx4 v[164:167], v220, s[20:23], 0 offen offset:1536 nt
s_waitcnt vmcnt(11)
buffer_load_dwordx4 v[168:171], v220, s[20:23], 0 offen offset:1792 nt
s_branch L_dn3
L_hi3:
s_cmp_ge_u32 s94, 10
s_cbranch_scc1 L_kb3
s_waitcnt vmcnt(13)
buffer_load_dwordx4 v[212:215], v221, s[24:27], 0 offen
s_waitcnt vmcnt(13)
buffer_load_dwordx4 v[140:143], v220, s[20:23], 0 offen offset:0 nt
s_waitcnt vmcnt(13)
buffer_load_dwordx4 v[144:147], v220, s[20:23], 0 offen offset:256 nt
s_waitcnt vmcnt(13)
buffer_load_dwordx4 v[148:151], v220, s[20:23], 0 offen offset:512 nt
s_waitcnt vmcnt(13)
buffer_load_dwordx4 v[152:155], v220, s[20:23], 0 offen offset:768 nt
s_waitcnt vmcnt(13)
buffer_load_dwordx4 v[156:159], v220, s[20:23], 0 offen offset:1024 nt
s_waitcnt vmcnt(13)
buffer_load_dwordx4 v[160:163], v220, s[20:23], 0 offen offset:1280 nt
s_waitcnt vmcnt(13)
buffer_load_dwordx4 v[164:167], v220, s[20:23], 0 offen offset:1536 nt
s_waitcnt vmcnt(13)
buffer_load_dwordx4 v[168:171], v220, s[20:23], 0 offen offset:1792 nt
s_branch L_dn3
L_kb3:
s_waitcnt vmcnt(19)
buffer_load_dwordx4 v[212:215], v221, s[24:27], 0 offen
s_waitcnt vmcnt(19)
buffer_load_dwordx4 v[140:143], v220, s[20:23], 0 offen offset:0 nt
s_waitcnt vmcnt(19)
buffer_load_dwordx4 v[144:147], v220, s[20:23], 0 offen offset:256 nt
s_waitcnt vmcnt(19)
buffer_load_dwordx4 v[148:151], v220, s[20:23], 0 offen offset:512 nt
s_waitcnt vmcnt(19)
buffer_load_dwordx4 v[152:155], v220, s[20:23], 0 offen offset:768 nt
s_waitcnt vmcnt(19)
buffer_load_dwordx4 v[156:159], v220, s[20:23], 0 offen offset:1024 nt
s_waitcnt vmcnt(19)
buffer_load_dwordx4 v[160:163], v220, s[20:23], 0 offen offset:1280 nt
s_waitcnt vmcnt(19)
buffer_load_dwordx4 v[164:167], v220, s[20:23], 0 offen offset:1536 nt
s_waitcnt vmcnt(19)
buffer_load_dwordx4 v[168:171], v220, s[20:23], 0 offen offset:1792 nt
L_dn3:
s_add_u32 s34, s34, 1
s_xor_b32 s35, s35, 0x25
s_lshl_b32 s28, s35, 11
s_lshl_b32 s29, s35, 4
v_xor_b32 v220, s28, v1
v_xor_b32 v221, s29, v2
s_waitcnt vmcnt(27)
v_perm_b32 v4, v176, v172, s31
v_perm_b32 v5, v184, v180, s31
v_perm_b32 v6, v192, v188, s31
v_perm_b32 v7, v200, v196, s31
v_perm_b32 v8, v176, v172, s32
v_perm_b32 v9, v184, v180, s32
v_perm_b32 v10, v192, v188, s32
v_perm_b32 v11, v200, v196, s32
v_mfma_f32_16x16x32_bf16 v[12:15], v[4:7], v[216:219], v[12:15]
v_perm_b32 v4, v177, v173, s31
v_perm_b32 v5, v185, v181, s31
v_perm_b32 v6, v193, v189, s31
v_perm_b32 v7, v201, v197, s31
v_mfma_f32_16x16x32_bf16 v[16:19], v[8:11], v[216:219], v[16:19]
v_perm_b32 v8, v177, v173, s32
v_perm_b32 v9, v185, v181, s32
v_perm_b32 v10, v193, v189, s32
v_perm_b32 v11, v201, v197, s32
v_mfma_f32_16x16x32_bf16 v[20:23], v[4:7], v[216:219], v[20:23]
v_perm_b32 v4, v178, v174, s31
v_perm_b32 v5, v186, v182, s31
v_perm_b32 v6, v194, v190, s31
v_perm_b32 v7, v202, v198, s31
v_mfma_f32_16x16x32_bf16 v[24:27], v[8:11], v[216:219], v[24:27]
v_perm_b32 v8, v178, v174, s32
v_perm_b32 v9, v186, v182, s32
v_perm_b32 v10, v194, v190, s32
v_perm_b32 v11, v202, v198, s32
v_mfma_f32_16x16x32_bf16 v[28:31], v[4:7], v[216:219], v[28:31]
v_perm_b32 v4, v179, v175, s31
v_perm_b32 v5, v187, v183, s31
v_perm_b32 v6, v195, v191, s31
v_perm_b32 v7, v203, v199, s31
v_mfma_f32_16x16x32_bf16 v[32:35], v[8:11], v[216:219], v[32:35]
v_perm_b32 v8, v179, v175, s32
v_perm_b32 v9, v187, v183, s32
v_perm_b32 v10, v195, v191, s32
v_perm_b32 v11, v203, v199, s32
v_mfma_f32_16x16x32_bf16 v[36:39], v[4:7], v[216:219], v[36:39]
s_nop 1
v_mfma_f32_16x16x32_bf16 v[40:43], v[8:11], v[216:219], v[40:43]
s_cmp_eq_u32 s93, 3
s_cbranch_scc0 L_np4
v_mov_b32 v71, s92
buffer_store_dword v71, v68, s[88:91], 0 offen
L_np4:
s_add_u32 s92, s92, 1
s_cmp_ge_u32 s94, 5
s_cbranch_scc1 L_hi4
s_cmp_ge_u32 s94, 1
s_cbranch_scc1 L_ka4
s_waitcnt vmcnt(10)
buffer_load_dwordx4 v[216:219], v221, s[24:27], 0 offen
s_waitcnt vmcnt(10)
buffer_load_dwordx4 v[172:175], v220, s[20:23], 0 offen offset:0 nt
s_waitcnt vmcnt(10)
buffer_load_dwordx4 v[176:179], v220, s[20:23], 0 offen offset:256 nt
s_waitcnt vmcnt(10)
buffer_load_dwordx4 v[180:183], v220, s[20:23], 0 offen offset:512 nt
s_waitcnt vmcnt(10)
buffer_load_dwordx4 v[184:187], v220, s[20:23], 0 offen offset:768 nt
s_waitcnt vmcnt(10)
buffer_load_dwordx4 v[188:191], v220, s[20:23], 0 offen offset:1024 nt
s_waitcnt vmcnt(10)
buffer_load_dwordx4 v[192:195], v220, s[20:23], 0 offen offset:1280 nt
s_waitcnt vmcnt(10)
buffer_load_dwordx4 v[196:199], v220, s[20:23], 0 offen offset:1536 nt
s_waitcnt vmcnt(10)
buffer_load_dwordx4 v[200:203], v220, s[20:23], 0 offen offset:1792 nt
s_branch L_dn4
L_ka4:
s_waitcnt vmcnt(11)
buffer_load_dwordx4 v[216:219], v221, s[24:27], 0 offen
s_waitcnt vmcnt(11)
buffer_load_dwordx4 v[172:175], v220, s[20:23], 0 offen offset:0 nt
s_waitcnt vmcnt(11)
buffer_load_dwordx4 v[176:179], v220, s[20:23], 0 offen offset:256 nt
s_waitcnt vmcnt(11)
buffer_load_dwordx4 v[180:183], v220, s[20:23], 0 offen offset:512 nt
s_waitcnt vmcnt(11)
buffer_load_dwordx4 v[184:187], v220, s[20:23], 0 offen offset:768 nt
s_waitcnt vmcnt(11)
buffer_load_dwordx4 v[188:191], v220, s[20:23], 0 offen offset:1024 nt
s_waitcnt vmcnt(11)
buffer_load_dwordx4 v[192:195], v220, s[20:23], 0 offen offset:1280 nt
s_waitcnt vmcnt(11)
buffer_load_dwordx4 v[196:199], v220, s[20:23], 0 offen offset:1536 nt
s_waitcnt vmcnt(11)
buffer_load_dwordx4 v[200:203], v220, s[20:23], 0 offen offset:1792 nt
s_branch L_dn4
L_hi4:
s_cmp_ge_u32 s94, 9
s_cbranch_scc1 L_kb4
s_waitcnt vmcnt(13)
buffer_load_dwordx4 v[216:219], v221, s[24:27], 0 offen
s_waitcnt vmcnt(13)
buffer_load_dwordx4 v[172:175], v220, s[20:23], 0 offen offset:0 nt
s_waitcnt vmcnt(13)
buffer_load_dwordx4 v[176:179], v220, s[20:23], 0 offen offset:256 nt
s_waitcnt vmcnt(13)
buffer_load_dwordx4 v[180:183], v220, s[20:23], 0 offen offset:512 nt
s_waitcnt vmcnt(13)
buffer_load_dwordx4 v[184:187], v220, s[20:23], 0 offen offset:768 nt
s_waitcnt vmcnt(13)
buffer_load_dwordx4 v[188:191], v220, s[20:23], 0 offen offset:1024 nt
s_waitcnt vmcnt(13)
buffer_load_dwordx4 v[192:195], v220, s[20:23], 0 offen offset:1280 nt
s_waitcnt vmcnt(13)
buffer_load_dwordx4 v[196:199], v220, s[20:23], 0 offen offset:1536 nt
s_waitcnt vmcnt(13)
buffer_load_dwordx4 v[200:203], v220, s[20:23], 0 offen offset:1792 nt
s_branch L_dn4
L_kb4:
s_waitcnt vmcnt(19)
buffer_load_dwordx4 v[216:219], v221, s[24:27], 0 offen
s_waitcnt vmcnt(19)
buffer_load_dwordx4 v[172:175], v220, s[20:23], 0 offen offset:0 nt
s_waitcnt vmcnt(19)
buffer_load_dwordx4 v[176:179], v220, s[20:23], 0 offen offset:256 nt
s_waitcnt vmcnt(19)
buffer_load_dwordx4 v[180:183], v220, s[20:23], 0 offen offset:512 nt
s_waitcnt vmcnt(19)
buffer_load_dwordx4 v[184:187], v220, s[20:23], 0 offen offset:768 nt
s_waitcnt vmcnt(19)
buffer_load_dwordx4 v[188:191], v220, s[20:23], 0 offen offset:1024 nt
s_waitcnt vmcnt(19)
buffer_load_dwordx4 v[192:195], v220, s[20:23], 0 offen offset:1280 nt
s_waitcnt vmcnt(19)
buffer_load_dwordx4 v[196:199], v220, s[20:23], 0 offen offset:1536 nt
s_waitcnt vmcnt(19)
buffer_load_dwordx4 v[200:203], v220, s[20:23], 0 offen offset:1792 nt
L_dn4:
s_add_u32 s34, s34, 1
s_ff1_i32_b32 s36, s34
s_min_u32 s36, s36, 6
s_mul_i32 s36, s36, 12
s_sub_u32 s36, s36, 24
s_lshr_b64 s[36:37], s[78:79], s36
s_and_b32 s36, s36, 4095
s_xor_b32 s35, s35, s36
s_lshl_b32 s28, s35, 11
s_lshl_b32 s29, s35, 4
v_xor_b32 v220, s28, v1
v_xor_b32 v221, s29, v2
s_sub_u32 s30, s30, 1
s_cmp_lg_u32 s30, 0
s_cbranch_scc1 L_loop0
s_nop 7
v_cvt_pk_bf16_f32 v4, v12, v16
v_cvt_pk_bf16_f32 v5, v20, v24
v_cvt_pk_bf16_f32 v6, v28, v32
v_cvt_pk_bf16_f32 v7, v36, v40
s_nop 1
v_mfma_f32_16x16x32_bf16 v[64:67], v[4:7], v[44:47], 0
v_cvt_pk_bf16_f32 v8, v13, v17
v_cvt_pk_bf16_f32 v9, v21, v25
v_cvt_pk_bf16_f32 v10, v29, v33
v_cvt_pk_bf16_f32 v11, v37, v41
s_nop 1
v_mfma_f32_16x16x32_bf16 v[64:67], v[8:11], v[48:51], v[64:67]
v_cvt_pk_bf16_f32 v4, v14, v18
v_cvt_pk_bf16_f32 v5, v22, v26
v_cvt_pk_bf16_f32 v6, v30, v34
v_cvt_pk_bf16_f32 v7, v38, v42
s_nop 1
v_mfma_f32_16x16x32_bf16 v[64:67], v[4:7], v[52:55], v[64:67]
v_cvt_pk_bf16_f32 v8, v15, v19
v_cvt_pk_bf16_f32 v9, v23, v27
v_cvt_pk_bf16_f32 v10, v31, v35
v_cvt_pk_bf16_f32 v11, v39, v43
s_nop 1
v_mfma_f32_16x16x32_bf16 v[64:67], v[8:11], v[56:59], v[64:67]
v_mov_b32 v12, 0
v_mov_b32 v13, 0
v_mov_b32 v14, 0
v_mov_b32 v15, 0
v_mov_b32 v16, 0
v_mov_b32 v17, 0
v_mov_b32 v18, 0
v_mov_b32 v19, 0
v_mov_b32 v20, 0
v_mov_b32 v21, 0
v_mov_b32 v22, 0
v_mov_b32 v23, 0
v_mov_b32 v24, 0
v_mov_b32 v25, 0
v_mov_b32 v26, 0
v_mov_b32 v27, 0
v_mov_b32 v28, 0
v_mov_b32 v29, 0
v_mov_b32 v30, 0
v_mov_b32 v31, 0
v_mov_b32 v32, 0
v_mov_b32 v33, 0
v_mov_b32 v34, 0
v_mov_b32 v35, 0
v_mov_b32 v36, 0
v_mov_b32 v37, 0
v_mov_b32 v38, 0
v_mov_b32 v39, 0
v_mov_b32 v40, 0
v_mov_b32 v41, 0
v_mov_b32 v42, 0
v_mov_b32 v43, 0
v_cvt_pk_bf16_f32 v4, v64, v65
v_cvt_pk_bf16_f32 v5, v66, v67
v_lshlrev_b32 v6, 16, v4
v_and_b32 v7, 0xffff0000, v4
v_lshlrev_b32 v8, 16, v5
v_and_b32 v9, 0xffff0000, v5
s_mov_b32 s36, 0x3db504f3
v_mul_f32 v6, s36, v6
v_mul_f32 v7, s36, v7
v_mul_f32 v8, s36, v8
v_mul_f32 v9, s36, v9
v_cvt_pk_bf16_f32 v4, v6, v7
v_cvt_pk_bf16_f32 v5, v8, v9
v_lshlrev_b32 v6, 16, v4
v_and_b32 v7, 0xffff0000, v4
v_lshlrev_b32 v8, 16, v5
v_and_b32 v9, 0xffff0000, v5
v_max_f32 v4, v6, v7
v_max3_f32 v4, v4, v8, v9
v_mov_b32 v5, v4
s_nop 1
v_permlane32_swap_b32 v4, v5
s_nop 1
v_max_f32 v4, v4, v5
v_mov_b32 v5, v4
s_nop 1
v_permlane16_swap_b32 v4, v5
s_nop 1
v_max_f32 v4, v4, v5
s_mov_b32 s36, 0x3fb8aa3b
v_sub_f32 v6, v6, v4
v_sub_f32 v7, v7, v4
v_sub_f32 v8, v8, v4
v_sub_f32 v9, v9, v4
v_mul_f32 v6, s36, v6
v_mul_f32 v7, s36, v7
v_mul_f32 v8, s36, v8
v_mul_f32 v9, s36, v9
v_exp_f32 v6, v6
v_exp_f32 v7, v7
v_exp_f32 v8, v8
v_exp_f32 v9, v9
s_nop 0
v_add_f32 v4, v6, v7
v_add_f32 v5, v8, v9
v_add_f32 v4, v4, v5
v_mov_b32 v5, v4
s_nop 1
v_permlane32_swap_b32 v4, v5
s_nop 1
v_add_f32 v4, v4, v5
v_mov_b32 v5, v4
s_nop 1
v_permlane16_swap_b32 v4, v5
s_nop 1
v_add_f32 v4, v4, v5
v_rcp_f32 v4, v4
s_nop 0
v_mul_f32 v6, v4, v6
v_mul_f32 v7, v4, v7
v_mul_f32 v8, v4, v8
v_mul_f32 v9, v4, v9
v_cvt_pk_bf16_f32 v60, v6, v7
v_cvt_pk_bf16_f32 v61, v8, v9
s_mov_b32 s30, 32
L_loop1:
s_cmp_eq_u32 s30, 1
s_cbranch_scc0 L_nosw1
v_mov_b32 v71, 288
buffer_store_dword v71, v68, s[88:91], 0 offen
L_nosw1:
s_waitcnt vmcnt(27)
v_perm_b32 v4, v80, v76, s31
v_perm_b32 v5, v88, v84, s31
v_perm_b32 v6, v96, v92, s31
v_perm_b32 v7, v104, v100, s31
v_perm_b32 v8, v80, v76, s32
v_perm_b32 v9, v88, v84, s32
v_perm_b32 v10, v96, v92, s32
v_perm_b32 v11, v104, v100, s32
v_mfma_f32_16x16x32_bf16 v[12:15], v[204:207], v[4:7], v[12:15]
v_perm_b32 v4, v81, v77, s31
v_perm_b32 v5, v89, v85, s31
v_perm_b32 v6, v97, v93, s31
v_perm_b32 v7, v105, v101, s31
v_mfma_f32_16x16x32_bf16 v[16:19], v[204:207], v[8:11], v[16:19]
v_perm_b32 v8, v81, v77, s32
v_perm_b32 v9, v89, v85, s32
v_perm_b32 v10, v97, v93, s32
v_perm_b32 v11, v105, v101, s32
v_mfma_f32_16x16x32_bf16 v[20:23], v[204:207], v[4:7], v[20:23]
v_perm_b32 v4, v82, v78, s31
v_perm_b32 v5, v90, v86, s31
v_perm_b32 v6, v98, v94, s31
v_perm_b32 v7, v106, v102, s31
v_mfma_f32_16x16x32_bf16 v[24:27], v[204:207], v[8:11], v[24:27]
v_perm_b32 v8, v82, v78, s32
v_perm_b32 v9, v90, v86, s32
v_perm_b32 v10, v98, v94, s32
v_perm_b32 v11, v106, v102, s32
v_mfma_f32_16x16x32_bf16 v[28:31], v[204:207], v[4:7], v[28:31]
v_perm_b32 v4, v83, v79, s31
v_perm_b32 v5, v91, v87, s31
v_perm_b32 v6, v99, v95, s31
v_perm_b32 v7, v107, v103, s31
v_mfma_f32_16x16x32_bf16 v[32:35], v[204:207], v[8:11], v[32:35]
v_perm_b32 v8, v83, v79, s32
v_perm_b32 v9, v91, v87, s32
v_perm_b32 v10, v99, v95, s32
v_perm_b32 v11, v107, v103, s32
v_mfma_f32_16x16x32_bf16 v[36:39], v[204:207], v[4:7], v[36:39]
s_nop 1
v_mfma_f32_16x16x32_bf16 v[40:43], v[204:207], v[8:11], v[40:43]
s_cmp_eq_u32 s30, 1
s_cbranch_scc1 L_ts0
s_cmp_eq_u32 s93, 0
s_cbranch_scc0 L_np5
v_mov_b32 v71, s92
buffer_store_dword v71, v68, s[88:91], 0 offen
L_np5:
s_mov_b32 s96, s92
buffer_load_dword v69, v70, s[88:91], 0 offen sc1
s_add_u32 s92, s92, 1
s_cmp_ge_u32 s94, 8
s_cbranch_scc1 L_hi5
s_cmp_ge_u32 s94, 4
s_cbranch_scc1 L_ka5
s_waitcnt vmcnt(10)
buffer_load_dwordx4 v[204:207], v221, s[24:27], 0 offen
s_waitcnt vmcnt(10)
buffer_load_dwordx4 v[76:79], v220, s[20:23], 0 offen offset:0 nt
s_waitcnt vmcnt(10)
buffer_load_dwordx4 v[80:83], v220, s[20:23], 0 offen offset:256 nt
s_waitcnt vmcnt(10)
buffer_load_dwordx4 v[84:87], v220, s[20:23], 0 offen offset:512 nt
s_waitcnt vmcnt(10)
buffer_load_dwordx4 v[88:91], v220, s[20:23], 0 offen offset:768 nt
s_waitcnt vmcnt(10)
buffer_load_dwordx4 v[92:95], v220, s[20:23], 0 offen offset:1024 nt
s_waitcnt vmcnt(10)
buffer_load_dwordx4 v[96:99], v220, s[20:23], 0 offen offset:1280 nt
s_waitcnt vmcnt(10)
buffer_load_dwordx4 v[100:103], v220, s[20:23], 0 offen offset:1536 nt
s_waitcnt vmcnt(10)
buffer_load_dwordx4 v[104:107], v220, s[20:23], 0 offen offset:1792 nt
s_branch L_dn5
L_ka5:
s_waitcnt vmcnt(11)
buffer_load_dwordx4 v[204:207], v221, s[24:27], 0 offen
s_waitcnt vmcnt(11)
buffer_load_dwordx4 v[76:79], v220, s[20:23], 0 offen offset:0 nt
s_waitcnt vmcnt(11)
buffer_load_dwordx4 v[80:83], v220, s[20:23], 0 offen offset:256 nt
s_waitcnt vmcnt(11)
buffer_load_dwordx4 v[84:87], v220, s[20:23], 0 offen offset:512 nt
s_waitcnt vmcnt(11)
buffer_load_dwordx4 v[88:91], v220, s[20:23], 0 offen offset:768 nt
s_waitcnt vmcnt(11)
buffer_load_dwordx4 v[92:95], v220, s[20:23], 0 offen offset:1024 nt
s_waitcnt vmcnt(11)
buffer_load_dwordx4 v[96:99], v220, s[20:23], 0 offen offset:1280 nt
s_waitcnt vmcnt(11)
buffer_load_dwordx4 v[100:103], v220, s[20:23], 0 offen offset:1536 nt
s_waitcnt vmcnt(11)
buffer_load_dwordx4 v[104:107], v220, s[20:23], 0 offen offset:1792 nt
s_branch L_dn5
L_hi5:
s_cmp_ge_u32 s94, 12
s_cbranch_scc1 L_kb5
s_waitcnt vmcnt(13)
buffer_load_dwordx4 v[204:207], v221, s[24:27], 0 offen
s_waitcnt vmcnt(13)
buffer_load_dwordx4 v[76:79], v220, s[20:23], 0 offen offset:0 nt
s_waitcnt vmcnt(13)
buffer_load_dwordx4 v[80:83], v220, s[20:23], 0 offen offset:256 nt
s_waitcnt vmcnt(13)
buffer_load_dwordx4 v[84:87], v220, s[20:23], 0 offen offset:512 nt
s_waitcnt vmcnt(13)
buffer_load_dwordx4 v[88:91], v220, s[20:23], 0 offen offset:768 nt
s_waitcnt vmcnt(13)
buffer_load_dwordx4 v[92:95], v220, s[20:23], 0 offen offset:1024 nt
s_waitcnt vmcnt(13)
buffer_load_dwordx4 v[96:99], v220, s[20:23], 0 offen offset:1280 nt
s_waitcnt vmcnt(13)
buffer_load_dwordx4 v[100:103], v220, s[20:23], 0 offen offset:1536 nt
s_waitcnt vmcnt(13)
buffer_load_dwordx4 v[104:107], v220, s[20:23], 0 offen offset:1792 nt
s_branch L_dn5
L_kb5:
s_waitcnt vmcnt(19)
buffer_load_dwordx4 v[204:207], v221, s[24:27], 0 offen
s_waitcnt vmcnt(19)
buffer_load_dwordx4 v[76:79], v220, s[20:23], 0 offen offset:0 nt
s_waitcnt vmcnt(19)
buffer_load_dwordx4 v[80:83], v220, s[20:23], 0 offen offset:256 nt
s_waitcnt vmcnt(19)
buffer_load_dwordx4 v[84:87], v220, s[20:23], 0 offen offset:512 nt
s_waitcnt vmcnt(19)
buffer_load_dwordx4 v[88:91], v220, s[20:23], 0 offen offset:768 nt
s_waitcnt vmcnt(19)
buffer_load_dwordx4 v[92:95], v220, s[20:23], 0 offen offset:1024 nt
s_waitcnt vmcnt(19)
buffer_load_dwordx4 v[96:99], v220, s[20:23], 0 offen offset:1280 nt
s_waitcnt vmcnt(19)
buffer_load_dwordx4 v[100:103], v220, s[20:23], 0 offen offset:1536 nt
s_waitcnt vmcnt(19)
buffer_load_dwordx4 v[104:107], v220, s[20:23], 0 offen offset:1792 nt
L_dn5:
s_add_u32 s34, s34, 1
s_xor_b32 s35, s35, 0x25
s_lshl_b32 s28, s35, 11
s_lshl_b32 s29, s35, 4
v_xor_b32 v220, s28, v1
v_xor_b32 v221, s29, v2
L_ts0:
s_cmp_eq_u32 s30, 1
s_cbranch_scc0 L_tw1
s_waitcnt vmcnt(18)
L_tw1:
s_waitcnt vmcnt(27)
v_perm_b32 v4, v112, v108, s31
v_perm_b32 v5, v120, v116, s31
v_perm_b32 v6, v128, v124, s31
v_perm_b32 v7, v136, v132, s31
v_perm_b32 v8, v112, v108, s32
v_perm_b32 v9, v120, v116, s32
v_perm_b32 v10, v128, v124, s32
v_perm_b32 v11, v136, v132, s32
v_mfma_f32_16x16x32_bf16 v[12:15], v[208:211], v[4:7], v[12:15]
v_perm_b32 v4, v113, v109, s31
v_perm_b32 v5, v121, v117, s31
v_perm_b32 v6, v129, v125, s31
v_perm_b32 v7, v137, v133, s31
v_mfma_f32_16x16x32_bf16 v[16:19], v[208:211], v[8:11], v[16:19]
v_perm_b32 v8, v113, v109, s32
v_perm_b32 v9, v121, v117, s32
v_perm_b32 v10, v129, v125, s32
v_perm_b32 v11, v137, v133, s32
v_mfma_f32_16x16x32_bf16 v[20:23], v[208:211], v[4:7], v[20:23]
v_perm_b32 v4, v114, v110, s31
v_perm_b32 v5, v122, v118, s31
v_perm_b32 v6, v130, v126, s31
v_perm_b32 v7, v138, v134, s31
v_mfma_f32_16x16x32_bf16 v[24:27], v[208:211], v[8:11], v[24:27]
v_perm_b32 v8, v114, v110, s32
v_perm_b32 v9, v122, v118, s32
v_perm_b32 v10, v130, v126, s32
v_perm_b32 v11, v138, v134, s32
v_mfma_f32_16x16x32_bf16 v[28:31], v[208:211], v[4:7], v[28:31]
v_perm_b32 v4, v115, v111, s31
v_perm_b32 v5, v123, v119, s31
v_perm_b32 v6, v131, v127, s31
v_perm_b32 v7, v139, v135, s31
v_mfma_f32_16x16x32_bf16 v[32:35], v[208:211], v[8:11], v[32:35]
v_perm_b32 v8, v115, v111, s32
v_perm_b32 v9, v123, v119, s32
v_perm_b32 v10, v131, v127, s32
v_perm_b32 v11, v139, v135, s32
v_mfma_f32_16x16x32_bf16 v[36:39], v[208:211], v[4:7], v[36:39]
s_nop 1
v_mfma_f32_16x16x32_bf16 v[40:43], v[208:211], v[8:11], v[40:43]
s_cmp_eq_u32 s30, 1
s_cbranch_scc1 L_ts1
s_cmp_eq_u32 s93, 1
s_cbranch_scc0 L_np6
v_mov_b32 v71, s92
buffer_store_dword v71, v68, s[88:91], 0 offen
L_np6:
s_add_u32 s92, s92, 1
s_cmp_ge_u32 s94, 7
s_cbranch_scc1 L_hi6
s_cmp_ge_u32 s94, 3
s_cbranch_scc1 L_ka6
s_waitcnt vmcnt(10)
buffer_load_dwordx4 v[208:211], v221, s[24:27], 0 offen
s_waitcnt vmcnt(10)
buffer_load_dwordx4 v[108:111], v220, s[20:23], 0 offen offset:0 nt
s_waitcnt vmcnt(10)
buffer_load_dwordx4 v[112:115], v220, s[20:23], 0 offen offset:256 nt
s_waitcnt vmcnt(10)
buffer_load_dwordx4 v[116:119], v220, s[20:23], 0 offen offset:512 nt
s_waitcnt vmcnt(10)
buffer_load_dwordx4 v[120:123], v220, s[20:23], 0 offen offset:768 nt
s_waitcnt vmcnt(10)
buffer_load_dwordx4 v[124:127], v220, s[20:23], 0 offen offset:1024 nt
s_waitcnt vmcnt(10)
buffer_load_dwordx4 v[128:131], v220, s[20:23], 0 offen offset:1280 nt
s_waitcnt vmcnt(10)
buffer_load_dwordx4 v[132:135], v220, s[20:23], 0 offen offset:1536 nt
s_waitcnt vmcnt(10)
buffer_load_dwordx4 v[136:139], v220, s[20:23], 0 offen offset:1792 nt
s_branch L_dn6
L_ka6:
s_waitcnt vmcnt(11)
buffer_load_dwordx4 v[208:211], v221, s[24:27], 0 offen
s_waitcnt vmcnt(11)
buffer_load_dwordx4 v[108:111], v220, s[20:23], 0 offen offset:0 nt
s_waitcnt vmcnt(11)
buffer_load_dwordx4 v[112:115], v220, s[20:23], 0 offen offset:256 nt
s_waitcnt vmcnt(11)
buffer_load_dwordx4 v[116:119], v220, s[20:23], 0 offen offset:512 nt
s_waitcnt vmcnt(11)
buffer_load_dwordx4 v[120:123], v220, s[20:23], 0 offen offset:768 nt
s_waitcnt vmcnt(11)
buffer_load_dwordx4 v[124:127], v220, s[20:23], 0 offen offset:1024 nt
s_waitcnt vmcnt(11)
buffer_load_dwordx4 v[128:131], v220, s[20:23], 0 offen offset:1280 nt
s_waitcnt vmcnt(11)
buffer_load_dwordx4 v[132:135], v220, s[20:23], 0 offen offset:1536 nt
s_waitcnt vmcnt(11)
buffer_load_dwordx4 v[136:139], v220, s[20:23], 0 offen offset:1792 nt
s_branch L_dn6
L_hi6:
s_cmp_ge_u32 s94, 11
s_cbranch_scc1 L_kb6
s_waitcnt vmcnt(13)
buffer_load_dwordx4 v[208:211], v221, s[24:27], 0 offen
s_waitcnt vmcnt(13)
buffer_load_dwordx4 v[108:111], v220, s[20:23], 0 offen offset:0 nt
s_waitcnt vmcnt(13)
buffer_load_dwordx4 v[112:115], v220, s[20:23], 0 offen offset:256 nt
s_waitcnt vmcnt(13)
buffer_load_dwordx4 v[116:119], v220, s[20:23], 0 offen offset:512 nt
s_waitcnt vmcnt(13)
buffer_load_dwordx4 v[120:123], v220, s[20:23], 0 offen offset:768 nt
s_waitcnt vmcnt(13)
buffer_load_dwordx4 v[124:127], v220, s[20:23], 0 offen offset:1024 nt
s_waitcnt vmcnt(13)
buffer_load_dwordx4 v[128:131], v220, s[20:23], 0 offen offset:1280 nt
s_waitcnt vmcnt(13)
buffer_load_dwordx4 v[132:135], v220, s[20:23], 0 offen offset:1536 nt
s_waitcnt vmcnt(13)
buffer_load_dwordx4 v[136:139], v220, s[20:23], 0 offen offset:1792 nt
s_branch L_dn6
L_kb6:
s_waitcnt vmcnt(19)
buffer_load_dwordx4 v[208:211], v221, s[24:27], 0 offen
s_waitcnt vmcnt(19)
buffer_load_dwordx4 v[108:111], v220, s[20:23], 0 offen offset:0 nt
s_waitcnt vmcnt(19)
buffer_load_dwordx4 v[112:115], v220, s[20:23], 0 offen offset:256 nt
s_waitcnt vmcnt(19)
buffer_load_dwordx4 v[116:119], v220, s[20:23], 0 offen offset:512 nt
s_waitcnt vmcnt(19)
buffer_load_dwordx4 v[120:123], v220, s[20:23], 0 offen offset:768 nt
s_waitcnt vmcnt(19)
buffer_load_dwordx4 v[124:127], v220, s[20:23], 0 offen offset:1024 nt
s_waitcnt vmcnt(19)
buffer_load_dwordx4 v[128:131], v220, s[20:23], 0 offen offset:1280 nt
s_waitcnt vmcnt(19)
buffer_load_dwordx4 v[132:135], v220, s[20:23], 0 offen offset:1536 nt
s_waitcnt vmcnt(19)
buffer_load_dwordx4 v[136:139], v220, s[20:23], 0 offen offset:1792 nt
L_dn6:
s_add_u32 s34, s34, 1
s_xor_b32 s35, s35, 0x31
s_lshl_b32 s28, s35, 11
s_lshl_b32 s29, s35, 4
v_xor_b32 v220, s28, v1
v_xor_b32 v221, s29, v2
L_ts1:
s_cmp_eq_u32 s30, 1
s_cbranch_scc0 L_tw2
s_waitcnt vmcnt(9)
L_tw2:
s_waitcnt vmcnt(27)
v_perm_b32 v4, v144, v140, s31
v_perm_b32 v5, v152, v148, s31
v_perm_b32 v6, v160, v156, s31
v_perm_b32 v7, v168, v164, s31
v_perm_b32 v8, v144, v140, s32
v_perm_b32 v9, v152, v148, s32
v_perm_b32 v10, v160, v156, s32
v_perm_b32 v11, v168, v164, s32
v_mfma_f32_16x16x32_bf16 v[12:15], v[212:215], v[4:7], v[12:15]
v_perm_b32 v4, v145, v141, s31
v_perm_b32 v5, v153, v149, s31
v_perm_b32 v6, v161, v157, s31
v_perm_b32 v7, v169, v165, s31
v_mfma_f32_16x16x32_bf16 v[16:19], v[212:215], v[8:11], v[16:19]
v_perm_b32 v8, v145, v141, s32
v_perm_b32 v9, v153, v149, s32
v_perm_b32 v10, v161, v157, s32
v_perm_b32 v11, v169, v165, s32
v_mfma_f32_16x16x32_bf16 v[20:23], v[212:215], v[4:7], v[20:23]
v_perm_b32 v4, v146, v142, s31
v_perm_b32 v5, v154, v150, s31
v_perm_b32 v6, v162, v158, s31
v_perm_b32 v7, v170, v166, s31
v_mfma_f32_16x16x32_bf16 v[24:27], v[212:215], v[8:11], v[24:27]
v_perm_b32 v8, v146, v142, s32
v_perm_b32 v9, v154, v150, s32
v_perm_b32 v10, v162, v158, s32
v_perm_b32 v11, v170, v166, s32
v_mfma_f32_16x16x32_bf16 v[28:31], v[212:215], v[4:7], v[28:31]
v_perm_b32 v4, v147, v143, s31
v_perm_b32 v5, v155, v151, s31
v_perm_b32 v6, v163, v159, s31
v_perm_b32 v7, v171, v167, s31
v_mfma_f32_16x16x32_bf16 v[32:35], v[212:215], v[8:11], v[32:35]
v_perm_b32 v8, v147, v143, s32
v_perm_b32 v9, v155, v151, s32
v_perm_b32 v10, v163, v159, s32
v_perm_b32 v11, v171, v167, s32
v_mfma_f32_16x16x32_bf16 v[36:39], v[212:215], v[4:7], v[36:39]
s_nop 1
v_mfma_f32_16x16x32_bf16 v[40:43], v[212:215], v[8:11], v[40:43]
s_cmp_eq_u32 s30, 1
s_cbranch_scc1 L_ts2
s_waitcnt vmcnt(18)
v_add_u32_dpp v63, v69, v69 row_shr:1 row_mask:0xf bank_mask:0xf bound_ctrl:0
s_nop 1
v_add_u32_dpp v63, v63, v63 row_shr:2 row_mask:0xf bank_mask:0xf bound_ctrl:0
s_nop 1
v_add_u32_dpp v63, v63, v63 row_shr:4 row_mask:0xf bank_mask:0xf bound_ctrl:0
s_nop 1
v_add_u32_dpp v63, v63, v63 row_shr:8 row_mask:0xf bank_mask:0xf bound_ctrl:0
s_nop 1
v_readlane_b32 s95, v63, 15
v_readlane_b32 s36, v63, 31
s_mul_i32 s37, s96, 31
s_add_i32 s95, s95, s36
s_sub_i32 s36, s37, s95
v_readlane_b32 s85, v69, 0
s_sub_i32 s36, s36, 50
s_add_i32 s36, s36, s85
s_add_i32 s85, s85, s87
s_cmp_ge_u32 s96, 224
s_cselect_b32 s37, 8, 4
s_mul_i32 s36, s36, s37
s_cselect_b32 s37, 7, 6
s_mul_i32 s85, s85, s37
s_sub_i32 s36, s36, s85
s_ashr_i32 s36, s36, 6
s_sub_i32 s36, 6, s36
s_cmp_lt_u32 s96, 8
s_cselect_b32 s37, 2, 0
s_add_i32 s36, s36, s37
s_max_i32 s36, s36, 0
s_min_i32 s94, s36, 12
s_sub_u32 s36, s96, s84
s_cmp_le_u32 s36, 12
s_cbranch_scc0 L_gxd7
s_cmp_eq_u32 s36, 0
s_cbranch_scc0 L_gx17
s_memrealtime s[100:101]
v_readlane_b32 s37, v69, 0
s_mul_i32 s36, s96, 31
s_sub_i32 s37, s95, s37
s_sub_i32 s37, s37, s36
s_mul_i32 s37, s37, 57
s_ashr_i32 s37, s37, 5
s_waitcnt lgkmcnt(0)
s_sub_u32 s98, s100, s37
v_mov_b32 v63, s98
buffer_atomic_swap v63, v72, s[88:91], 0 offen sc1
s_branch L_gxd7
L_gx17:
s_cmp_eq_u32 s36, 8
s_cbranch_scc0 L_gx27
buffer_load_dword v74, v73, s[88:91], 0 offen sc1
s_branch L_gxd7
L_gx27:
s_cmp_eq_u32 s36, 12
s_cbranch_scc0 L_gxd7
v_subrev_u32 v63, s98, v74
s_mov_b32 s36, 1200
v_add_u32 v74, 600, v63
v_cmp_ge_u32 vcc, s36, v74
s_nop 3
s_and_b32 s36, vcc_lo, 0xff
s_cmp_eq_u32 s36, 0xff
s_cbranch_scc0 L_gxa7
v_add_u32_dpp v63, v63, v63 row_shr:1 row_mask:0xf bank_mask:0xf bound_ctrl:0
s_nop 1
v_add_u32_dpp v63, v63, v63 row_shr:2 row_mask:0xf bank_mask:0xf bound_ctrl:0
s_nop 1
v_add_u32_dpp v63, v63, v63 row_shr:4 row_mask:0xf bank_mask:0xf bound_ctrl:0
s_nop 1
v_readlane_b32 s36, v63, 7
s_nop 0
s_mul_i32 s37, s36, -2
s_ashr_i32 s37, s37, 9
s_add_i32 s99, s99, s37
s_max_i32 s99, s99, -60
s_min_i32 s99, s99, 60
s_mul_i32 s36, s36, -12
s_ashr_i32 s36, s36, 9
s_add_i32 s36, s36, s99
s_max_i32 s36, s36, -80
s_min_i32 s36, s36, 80
v_mov_b32 v63, s36
buffer_store_dword v63, v75, s[88:91], 0 offen
L_gxa7:
s_add_u32 s84, s84, 24
s_cmp_ge_u32 s84, 248
s_cselect_b32 s84, 0x7fff0000, s84
v_xor_b32 v72, 32, v72
v_xor_b32 v73, 32, v73
L_gxd7:
s_cmp_eq_u32 s93, 2
s_cbranch_scc0 L_np7
v_mov_b32 v71, s92
buffer_store_dword v71, v68, s[88:91], 0 offen
L_np7:
s_add_u32 s92, s92, 1
s_cmp_ge_u32 s94, 6
s_cbranch_scc1 L_hi7
s_cmp_ge_u32 s94, 2
s_cbranch_scc1 L_ka7
s_waitcnt vmcnt(10)
buffer_load_dwordx4 v[212:215], v221, s[24:27], 0 offen
s_waitcnt vmcnt(10)
buffer_load_dwordx4 v[140:143], v220, s[20:23], 0 offen offset:0 nt
s_waitcnt vmcnt(10)
buffer_load_dwordx4 v[144:147], v220, s[20:23], 0 offen offset:256 nt
s_waitcnt vmcnt(10)
buffer_load_dwordx4 v[148:151], v220, s[20:23], 0 offen offset:512 nt
s_waitcnt vmcnt(10)
buffer_load_dwordx4 v[152:155], v220, s[20:23], 0 offen offset:768 nt
s_waitcnt vmcnt(10)
buffer_load_dwordx4 v[156:159], v220, s[20:23], 0 offen offset:1024 nt
s_waitcnt vmcnt(10)
buffer_load_dwordx4 v[160:163], v220, s[20:23], 0 offen offset:1280 nt
s_waitcnt vmcnt(10)
buffer_load_dwordx4 v[164:167], v220, s[20:23], 0 offen offset:1536 nt
s_waitcnt vmcnt(10)
buffer_load_dwordx4 v[168:171], v220, s[20:23], 0 offen offset:1792 nt
s_branch L_dn7
L_ka7:
s_waitcnt vmcnt(11)
buffer_load_dwordx4 v[212:215], v221, s[24:27], 0 offen
s_waitcnt vmcnt(11)
buffer_load_dwordx4 v[140:143], v220, s[20:23], 0 offen offset:0 nt
s_waitcnt vmcnt(11)
buffer_load_dwordx4 v[144:147], v220, s[20:23], 0 offen offset:256 nt
s_waitcnt vmcnt(11)
buffer_load_dwordx4 v[148:151], v220, s[20:23], 0 offen offset:512 nt
s_waitcnt vmcnt(11)
buffer_load_dwordx4 v[152:155], v220, s[20:23], 0 offen offset:768 nt
s_waitcnt vmcnt(11)
buffer_load_dwordx4 v[156:159], v220, s[20:23], 0 offen offset:1024 nt
s_waitcnt vmcnt(11)
buffer_load_dwordx4 v[160:163], v220, s[20:23], 0 offen offset:1280 nt
s_waitcnt vmcnt(11)
buffer_load_dwordx4 v[164:167], v220, s[20:23], 0 offen offset:1536 nt
s_waitcnt vmcnt(11)
buffer_load_dwordx4 v[168:171], v220, s[20:23], 0 offen offset:1792 nt
s_branch L_dn7
L_hi7:
s_cmp_ge_u32 s94, 10
s_cbranch_scc1 L_kb7
s_waitcnt vmcnt(13)
buffer_load_dwordx4 v[212:215], v221, s[24:27], 0 offen
s_waitcnt vmcnt(13)
buffer_load_dwordx4 v[140:143], v220, s[20:23], 0 offen offset:0 nt
s_waitcnt vmcnt(13)
buffer_load_dwordx4 v[144:147], v220, s[20:23], 0 offen offset:256 nt
s_waitcnt vmcnt(13)
buffer_load_dwordx4 v[148:151], v220, s[20:23], 0 offen offset:512 nt
s_waitcnt vmcnt(13)
buffer_load_dwordx4 v[152:155], v220, s[20:23], 0 offen offset:768 nt
s_waitcnt vmcnt(13)
buffer_load_dwordx4 v[156:159], v220, s[20:23], 0 offen offset:1024 nt
s_waitcnt vmcnt(13)
buffer_load_dwordx4 v[160:163], v220, s[20:23], 0 offen offset:1280 nt
s_waitcnt vmcnt(13)
buffer_load_dwordx4 v[164:167], v220, s[20:23], 0 offen offset:1536 nt
s_waitcnt vmcnt(13)
buffer_load_dwordx4 v[168:171], v220, s[20:23], 0 offen offset:1792 nt
s_branch L_dn7
L_kb7:
s_waitcnt vmcnt(19)
buffer_load_dwordx4 v[212:215], v221, s[24:27], 0 offen
s_waitcnt vmcnt(19)
buffer_load_dwordx4 v[140:143], v220, s[20:23], 0 offen offset:0 nt
s_waitcnt vmcnt(19)
buffer_load_dwordx4 v[144:147], v220, s[20:23], 0 offen offset:256 nt
s_waitcnt vmcnt(19)
buffer_load_dwordx4 v[148:151], v220, s[20:23], 0 offen offset:512 nt
s_waitcnt vmcnt(19)
buffer_load_dwordx4 v[152:155], v220, s[20:23], 0 offen offset:768 nt
s_waitcnt vmcnt(19)
buffer_load_dwordx4 v[156:159], v220, s[20:23], 0 offen offset:1024 nt
s_waitcnt vmcnt(19)
buffer_load_dwordx4 v[160:163], v220, s[20:23], 0 offen offset:1280 nt
s_waitcnt vmcnt(19)
buffer_load_dwordx4 v[164:167], v220, s[20:23], 0 offen offset:1536 nt
s_waitcnt vmcnt(19)
buffer_load_dwordx4 v[168:171], v220, s[20:23], 0 offen offset:1792 nt
L_dn7:
s_add_u32 s34, s34, 1
s_xor_b32 s35, s35, 0x25
s_lshl_b32 s28, s35, 11
s_lshl_b32 s29, s35, 4
v_xor_b32 v220, s28, v1
v_xor_b32 v221, s29, v2
L_ts2:
s_cmp_eq_u32 s30, 1
s_cbranch_scc0 L_tw3
s_waitcnt vmcnt(0)
L_tw3:
s_waitcnt vmcnt(27)
v_perm_b32 v4, v176, v172, s31
v_perm_b32 v5, v184, v180, s31
v_perm_b32 v6, v192, v188, s31
v_perm_b32 v7, v200, v196, s31
v_perm_b32 v8, v176, v172, s32
v_perm_b32 v9, v184, v180, s32
v_perm_b32 v10, v192, v188, s32
v_perm_b32 v11, v200, v196, s32
v_mfma_f32_16x16x32_bf16 v[12:15], v[216:219], v[4:7], v[12:15]
v_perm_b32 v4, v177, v173, s31
v_perm_b32 v5, v185, v181, s31
v_perm_b32 v6, v193, v189, s31
v_perm_b32 v7, v201, v197, s31
v_mfma_f32_16x16x32_bf16 v[16:19], v[216:219], v[8:11], v[16:19]
v_perm_b32 v8, v177, v173, s32
v_perm_b32 v9, v185, v181, s32
v_perm_b32 v10, v193, v189, s32
v_perm_b32 v11, v201, v197, s32
v_mfma_f32_16x16x32_bf16 v[20:23], v[216:219], v[4:7], v[20:23]
v_perm_b32 v4, v178, v174, s31
v_perm_b32 v5, v186, v182, s31
v_perm_b32 v6, v194, v190, s31
v_perm_b32 v7, v202, v198, s31
v_mfma_f32_16x16x32_bf16 v[24:27], v[216:219], v[8:11], v[24:27]
v_perm_b32 v8, v178, v174, s32
v_perm_b32 v9, v186, v182, s32
v_perm_b32 v10, v194, v190, s32
v_perm_b32 v11, v202, v198, s32
v_mfma_f32_16x16x32_bf16 v[28:31], v[216:219], v[4:7], v[28:31]
v_perm_b32 v4, v179, v175, s31
v_perm_b32 v5, v187, v183, s31
v_perm_b32 v6, v195, v191, s31
v_perm_b32 v7, v203, v199, s31
v_mfma_f32_16x16x32_bf16 v[32:35], v[216:219], v[8:11], v[32:35]
v_perm_b32 v8, v179, v175, s32
v_perm_b32 v9, v187, v183, s32
v_perm_b32 v10, v195, v191, s32
v_perm_b32 v11, v203, v199, s32
v_mfma_f32_16x16x32_bf16 v[36:39], v[216:219], v[4:7], v[36:39]
s_nop 1
v_mfma_f32_16x16x32_bf16 v[40:43], v[216:219], v[8:11], v[40:43]
s_cmp_eq_u32 s30, 1
s_cbranch_scc1 L_ts3
s_cmp_eq_u32 s93, 3
s_cbranch_scc0 L_np8
v_mov_b32 v71, s92
buffer_store_dword v71, v68, s[88:91], 0 offen
L_np8:
s_add_u32 s92, s92, 1
s_cmp_ge_u32 s94, 5
s_cbranch_scc1 L_hi8
s_cmp_ge_u32 s94, 1
s_cbranch_scc1 L_ka8
s_waitcnt vmcnt(10)
buffer_load_dwordx4 v[216:219], v221, s[24:27], 0 offen
s_waitcnt vmcnt(10)
buffer_load_dwordx4 v[172:175], v220, s[20:23], 0 offen offset:0 nt
s_waitcnt vmcnt(10)
buffer_load_dwordx4 v[176:179], v220, s[20:23], 0 offen offset:256 nt
s_waitcnt vmcnt(10)
buffer_load_dwordx4 v[180:183], v220, s[20:23], 0 offen offset:512 nt
s_waitcnt vmcnt(10)
buffer_load_dwordx4 v[184:187], v220, s[20:23], 0 offen offset:768 nt
s_waitcnt vmcnt(10)
buffer_load_dwordx4 v[188:191], v220, s[20:23], 0 offen offset:1024 nt
s_waitcnt vmcnt(10)
buffer_load_dwordx4 v[192:195], v220, s[20:23], 0 offen offset:1280 nt
s_waitcnt vmcnt(10)
buffer_load_dwordx4 v[196:199], v220, s[20:23], 0 offen offset:1536 nt
s_waitcnt vmcnt(10)
buffer_load_dwordx4 v[200:203], v220, s[20:23], 0 offen offset:1792 nt
s_branch L_dn8
L_ka8:
s_waitcnt vmcnt(11)
buffer_load_dwordx4 v[216:219], v221, s[24:27], 0 offen
s_waitcnt vmcnt(11)
buffer_load_dwordx4 v[172:175], v220, s[20:23], 0 offen offset:0 nt
s_waitcnt vmcnt(11)
buffer_load_dwordx4 v[176:179], v220, s[20:23], 0 offen offset:256 nt
s_waitcnt vmcnt(11)
buffer_load_dwordx4 v[180:183], v220, s[20:23], 0 offen offset:512 nt
s_waitcnt vmcnt(11)
buffer_load_dwordx4 v[184:187], v220, s[20:23], 0 offen offset:768 nt
s_waitcnt vmcnt(11)
buffer_load_dwordx4 v[188:191], v220, s[20:23], 0 offen offset:1024 nt
s_waitcnt vmcnt(11)
buffer_load_dwordx4 v[192:195], v220, s[20:23], 0 offen offset:1280 nt
s_waitcnt vmcnt(11)
buffer_load_dwordx4 v[196:199], v220, s[20:23], 0 offen offset:1536 nt
s_waitcnt vmcnt(11)
buffer_load_dwordx4 v[200:203], v220, s[20:23], 0 offen offset:1792 nt
s_branch L_dn8
L_hi8:
s_cmp_ge_u32 s94, 9
s_cbranch_scc1 L_kb8
s_waitcnt vmcnt(13)
buffer_load_dwordx4 v[216:219], v221, s[24:27], 0 offen
s_waitcnt vmcnt(13)
buffer_load_dwordx4 v[172:175], v220, s[20:23], 0 offen offset:0 nt
s_waitcnt vmcnt(13)
buffer_load_dwordx4 v[176:179], v220, s[20:23], 0 offen offset:256 nt
s_waitcnt vmcnt(13)
buffer_load_dwordx4 v[180:183], v220, s[20:23], 0 offen offset:512 nt
s_waitcnt vmcnt(13)
buffer_load_dwordx4 v[184:187], v220, s[20:23], 0 offen offset:768 nt
s_waitcnt vmcnt(13)
buffer_load_dwordx4 v[188:191], v220, s[20:23], 0 offen offset:1024 nt
s_waitcnt vmcnt(13)
buffer_load_dwordx4 v[192:195], v220, s[20:23], 0 offen offset:1280 nt
s_waitcnt vmcnt(13)
buffer_load_dwordx4 v[196:199], v220, s[20:23], 0 offen offset:1536 nt
s_waitcnt vmcnt(13)
buffer_load_dwordx4 v[200:203], v220, s[20:23], 0 offen offset:1792 nt
s_branch L_dn8
L_kb8:
s_waitcnt vmcnt(19)
buffer_load_dwordx4 v[216:219], v221, s[24:27], 0 offen
s_waitcnt vmcnt(19)
buffer_load_dwordx4 v[172:175], v220, s[20:23], 0 offen offset:0 nt
s_waitcnt vmcnt(19)
buffer_load_dwordx4 v[176:179], v220, s[20:23], 0 offen offset:256 nt
s_waitcnt vmcnt(19)
buffer_load_dwordx4 v[180:183], v220, s[20:23], 0 offen offset:512 nt
s_waitcnt vmcnt(19)
buffer_load_dwordx4 v[184:187], v220, s[20:23], 0 offen offset:768 nt
s_waitcnt vmcnt(19)
buffer_load_dwordx4 v[188:191], v220, s[20:23], 0 offen offset:1024 nt
s_waitcnt vmcnt(19)
buffer_load_dwordx4 v[192:195], v220, s[20:23], 0 offen offset:1280 nt
s_waitcnt vmcnt(19)
buffer_load_dwordx4 v[196:199], v220, s[20:23], 0 offen offset:1536 nt
s_waitcnt vmcnt(19)
buffer_load_dwordx4 v[200:203], v220, s[20:23], 0 offen offset:1792 nt
L_dn8:
s_add_u32 s34, s34, 1
s_ff1_i32_b32 s36, s34
s_min_u32 s36, s36, 6
s_mul_i32 s36, s36, 12
s_sub_u32 s36, s36, 24
s_lshr_b64 s[36:37], s[78:79], s36
s_and_b32 s36, s36, 4095
s_xor_b32 s35, s35, s36
s_lshl_b32 s28, s35, 11
s_lshl_b32 s29, s35, 4
v_xor_b32 v220, s28, v1
v_xor_b32 v221, s29, v2
L_ts3:
s_sub_u32 s30, s30, 1
s_cmp_lg_u32 s30, 0
s_cbranch_scc1 L_loop1
s_nop 7
v_cvt_pk_bf16_f32 v4, v12, v13
v_cvt_pk_bf16_f32 v5, v14, v15
s_nop 1
v_mfma_f32_16x16x16_bf16 v[76:79], v[60:61], v[4:5], 0
v_cvt_pk_bf16_f32 v6, v16, v17
v_cvt_pk_bf16_f32 v7, v18, v19
s_nop 1
v_mfma_f32_16x16x16_bf16 v[80:83], v[60:61], v[6:7], 0
v_cvt_pk_bf16_f32 v8, v20, v21
v_cvt_pk_bf16_f32 v9, v22, v23
s_nop 1
v_mfma_f32_16x16x16_bf16 v[84:87], v[60:61], v[8:9], 0
v_cvt_pk_bf16_f32 v10, v24, v25
v_cvt_pk_bf16_f32 v11, v26, v27
s_nop 1
v_mfma_f32_16x16x16_bf16 v[88:91], v[60:61], v[10:11], 0
v_cvt_pk_bf16_f32 v4, v28, v29
v_cvt_pk_bf16_f32 v5, v30, v31
s_nop 1
v_mfma_f32_16x16x16_bf16 v[92:95], v[60:61], v[4:5], 0
v_cvt_pk_bf16_f32 v6, v32, v33
v_cvt_pk_bf16_f32 v7, v34, v35
s_nop 1
v_mfma_f32_16x16x16_bf16 v[96:99], v[60:61], v[6:7], 0
v_cvt_pk_bf16_f32 v8, v36, v37
v_cvt_pk_bf16_f32 v9, v38, v39
s_nop 1
v_mfma_f32_16x16x16_bf16 v[100:103], v[60:61], v[8:9], 0
v_cvt_pk_bf16_f32 v10, v40, v41
v_cvt_pk_bf16_f32 v11, v42, v43
s_nop 1
v_mfma_f32_16x16x16_bf16 v[104:107], v[60:61], v[10:11], 0
s_nop 7
v_lshrrev_b32 v5, 4, v0
v_and_b32 v4, 15, v0
v_lshlrev_b32 v3, 10, v5
v_lshl_add_u32 v3, v4, 4, v3
v_cvt_pk_bf16_f32 v12, v76, v80
v_cvt_pk_bf16_f32 v13, v84, v88
v_cvt_pk_bf16_f32 v14, v92, v96
v_cvt_pk_bf16_f32 v15, v100, v104
buffer_store_dwordx4 v[12:15], v3, s[64:67], 0 offen offset:0
v_cvt_pk_bf16_f32 v16, v77, v81
v_cvt_pk_bf16_f32 v17, v85, v89
v_cvt_pk_bf16_f32 v18, v93, v97
v_cvt_pk_bf16_f32 v19, v101, v105
buffer_store_dwordx4 v[16:19], v3, s[64:67], 0 offen offset:256
v_cvt_pk_bf16_f32 v20, v78, v82
v_cvt_pk_bf16_f32 v21, v86, v90
v_cvt_pk_bf16_f32 v22, v94, v98
v_cvt_pk_bf16_f32 v23, v102, v106
buffer_store_dwordx4 v[20:23], v3, s[64:67], 0 offen offset:512
v_cvt_pk_bf16_f32 v24, v79, v83
v_cvt_pk_bf16_f32 v25, v87, v91
v_cvt_pk_bf16_f32 v26, v95, v99
v_cvt_pk_bf16_f32 v27, v103, v107
buffer_store_dwordx4 v[24:27], v3, s[64:67], 0 offen offset:768
L_end:
s_endpgm

.section .rodata,"a"
.p2align 6
.amdhsa_kernel standalone__low_rank_proj_linformer__sampling_kernel
  .amdhsa_next_free_vgpr 222
  .amdhsa_next_free_sgpr 102
  .amdhsa_accum_offset 224
  .amdhsa_group_segment_fixed_size 0
  .amdhsa_kernarg_size 64
  .amdhsa_user_sgpr_count 2
  .amdhsa_user_sgpr_kernarg_segment_ptr 1
  .amdhsa_system_sgpr_workgroup_id_x 1
  .amdhsa_float_denorm_mode_32 3
.end_amdhsa_kernel
```
